```python
import torch

def _softmax(x, axis=-1):
    return torch.softmax(x, dim=axis)
def _gelu(x):
    return torch.nn.functional.gelu(x, approximate="tanh")
def _silu(x):
    return torch.nn.functional.silu(x)
def _sigmoid(x):
    return torch.sigmoid(x)
def _layernorm(x, axis=-1, eps=1e-5):
    m = x.mean(dim=axis, keepdim=True)
    v = x.var(dim=axis, keepdim=True, unbiased=False)
    return (x - m) / torch.sqrt(v + eps)
def _scatter_add(tgt, idx, src, axis=0):
    return tgt.clone().index_add_(axis, idx, src)
def _segment_sum(src, seg, n):
    out = torch.zeros((n,) + src.shape[1:], dtype=src.dtype)
    return out.index_add_(0, seg, src)
def _pad(x, pw):
    flat = tuple(v for pair in reversed(pw) for v in pair)
    return torch.nn.functional.pad(x, flat)

kernel_name = 'sequential_preLN__spectral_gfnet__glu_gated_geglu__prompt'

def setup_inputs():

    _w = (lambda a: (lambda t: t.to(torch.bfloat16) if t.is_floating_point() else t)(torch.as_tensor(a)))
    def _A_setup():
        B, S, D = 1, 2048, 1024
        Df = D // 2 + 1
        return {
            "x": _w((lambda *s: torch.randn(*s, dtype=torch.bfloat16) * 0.05)(B, S, D)),
            "w_r": _w((lambda *s: torch.randn(*s, dtype=torch.bfloat16) * 0.4)(S, Df) * 0.02),
            "w_i": _w((lambda *s: torch.randn(*s, dtype=torch.bfloat16) * 0.4)(S, Df) * 0.02),
        }
    _A_in = _A_setup()

    def _B_setup():
        B, S, Dm, Df = 1, 2048, 1024, 3584
        return {
            "x": _w((lambda *s: torch.randn(*s, dtype=torch.bfloat16) * 0.05)(B, S, Dm)),
            "w_gate": _w((lambda *s: torch.randn(*s, dtype=torch.bfloat16) * 0.4)(Dm, Df) * (Dm ** -0.5)),
            "w_up": _w((lambda *s: torch.randn(*s, dtype=torch.bfloat16) * 0.4)(Dm, Df) * (Dm ** -0.5)),
            "w_down": _w((lambda *s: torch.randn(*s, dtype=torch.bfloat16) * 0.4)(Df, Dm) * (Df ** -0.5)),
        }
    _B_in = _B_setup()

    return {
        "A_x": _A_in["x"],
        "A_w_r": _A_in["w_r"],
        "A_w_i": _A_in["w_i"],
        "B_x": _B_in["x"],
        "B_w_gate": _B_in["w_gate"],
        "B_w_up": _B_in["w_up"],
        "B_w_down": _B_in["w_down"],
    }

def reference(A_x, A_w_r, A_w_i, B_x, B_w_gate, B_w_up, B_w_down):
    def _A_ref(x, w_r, w_i):
        B, S, D = x.shape
        X = (lambda x, axes=(-2,-1): torch.fft.rfft2(x.float(), dim=axes))(x, axes=(-2, -1))
        W = w_r + 1j * w_i
        X = X * W
        y = (lambda x, s, axes=(-2,-1): torch.fft.irfft2(x, s=s, dim=axes).to(torch.bfloat16))(X, (S, D), axes=(-2, -1))
        return y

    def _B_ref(x, w_gate, w_up, w_down):
        g = torch.einsum("bsd,df->bsf", x, w_gate)
        u = torch.einsum("bsd,df->bsf", x, w_up)
        h = _gelu(g) * u
        return torch.einsum("bsf,fd->bsd", h, w_down)

    x = A_x
    h = x + _A_ref(_layernorm(x, axis=-1), A_w_r, A_w_i)
    h2 = h + _B_ref(_layernorm(h, axis=-1), B_w_gate, B_w_up, B_w_down)
    return h2
```

```asm
; @launch kernel=k1_kernel grid=(416,1,1) block=(512,1,1) lds=33280
; @launch kernel=k2_kernel grid=(993,1,1) block=(256,1,1) lds=32768
; @launch kernel=k3_kernel grid=(256,1,1) block=(512,1,1) lds=33024
; @launch kernel=k4_kernel grid=(256,1,1) block=(512,1,1) lds=131072
; @launch kernel=k5_kernel grid=(256,1,1) block=(256,1,1) lds=131088
.amdgcn_target "amdgcn-amd-amdhsa--gfx950"
.text
.globl k1_kernel
.p2align 8
.type k1_kernel,@function
k1_kernel:
    s_cmp_ge_u32 s2, 256
    s_cbranch_scc1 K1_WT
    s_load_dwordx2 s[4:5], s[0:1], 0
    s_load_dwordx2 s[6:7], s[0:1], 72
    v_and_b32 v1, 63, v0
    v_lshrrev_b32 v2, 6, v0
    s_lshl_b32 s18, s2, 14
    v_lshlrev_b32 v3, 11, v2
    v_lshl_add_u32 v3, v1, 2, v3
    s_waitcnt lgkmcnt(0)
    s_mov_b32 s8, s4
    s_and_b32 s9, s5, 0xffff
    s_mov_b32 s10, 0x400000
    s_mov_b32 s11, 0x00020000
    buffer_load_dword v10, v3, s[8:11], s18 offen offset:0
    buffer_load_dword v11, v3, s[8:11], s18 offen offset:256
    buffer_load_dword v12, v3, s[8:11], s18 offen offset:512
    buffer_load_dword v13, v3, s[8:11], s18 offen offset:768
    buffer_load_dword v14, v3, s[8:11], s18 offen offset:1024
    buffer_load_dword v15, v3, s[8:11], s18 offen offset:1280
    buffer_load_dword v16, v3, s[8:11], s18 offen offset:1536
    buffer_load_dword v17, v3, s[8:11], s18 offen offset:1792
    s_mov_b32 s12, s6
    s_and_b32 s13, s7, 0xffff
    s_mov_b32 s14, 0x804000
    s_mov_b32 s15, 0x00020000
    s_mov_b32 s16, 0x3f3504f3
    s_mov_b32 s17, 0x3f3504f3
    s_mov_b32 s19, 0x3727c5ac
    v_mul_u32_u24 v4, 4128, v2
    v_lshl_add_u32 v3, v1, 3, v4
    s_waitcnt vmcnt(0)
    v_lshlrev_b32 v20, 16, v10
    v_and_b32 v21, 0xffff0000, v10
    v_lshlrev_b32 v22, 16, v11
    v_and_b32 v23, 0xffff0000, v11
    v_lshlrev_b32 v24, 16, v12
    v_and_b32 v25, 0xffff0000, v12
    v_lshlrev_b32 v26, 16, v13
    v_and_b32 v27, 0xffff0000, v13
    v_lshlrev_b32 v28, 16, v14
    v_and_b32 v29, 0xffff0000, v14
    v_lshlrev_b32 v30, 16, v15
    v_and_b32 v31, 0xffff0000, v15
    v_lshlrev_b32 v32, 16, v16
    v_and_b32 v33, 0xffff0000, v16
    v_lshlrev_b32 v34, 16, v17
    v_and_b32 v35, 0xffff0000, v17
    v_pk_add_f32 v[94:95], v[20:21], v[22:23]
    v_pk_add_f32 v[94:95], v[94:95], v[24:25]
    v_pk_add_f32 v[94:95], v[94:95], v[26:27]
    v_pk_add_f32 v[94:95], v[94:95], v[28:29]
    v_pk_add_f32 v[94:95], v[94:95], v[30:31]
    v_pk_add_f32 v[94:95], v[94:95], v[32:33]
    v_pk_add_f32 v[94:95], v[94:95], v[34:35]
    v_add_f32 v94, v94, v95
    s_nop 1
    v_add_f32_dpp v98, v94, v94 quad_perm:[1,0,3,2] row_mask:0xf bank_mask:0xf
    s_nop 1
    v_add_f32_dpp v94, v98, v98 quad_perm:[2,3,0,1] row_mask:0xf bank_mask:0xf
    s_nop 1
    v_add_f32_dpp v98, v94, v94 row_half_mirror row_mask:0xf bank_mask:0xf
    s_nop 1
    v_add_f32_dpp v94, v98, v98 row_mirror row_mask:0xf bank_mask:0xf
    s_nop 1
    v_readlane_b32 s24, v94, 0
    v_readlane_b32 s25, v94, 16
    v_readlane_b32 s26, v94, 32
    v_readlane_b32 s27, v94, 48
    s_nop 1
    v_mov_b32 v94, s24
    v_add_f32 v94, s25, v94
    v_add_f32 v94, s26, v94
    v_add_f32 v94, s27, v94
    v_mul_f32 v94, 0x3a800000, v94
    v_mov_b32 v95, v94
    v_pk_add_f32 v[98:99], v[20:21], v[94:95] neg_lo:[0,1] neg_hi:[0,1]
    v_pk_mul_f32 v[96:97], v[98:99], v[98:99]
    v_pk_add_f32 v[98:99], v[22:23], v[94:95] neg_lo:[0,1] neg_hi:[0,1]
    v_pk_fma_f32 v[96:97], v[98:99], v[98:99], v[96:97]
    v_pk_add_f32 v[98:99], v[24:25], v[94:95] neg_lo:[0,1] neg_hi:[0,1]
    v_pk_fma_f32 v[96:97], v[98:99], v[98:99], v[96:97]
    v_pk_add_f32 v[98:99], v[26:27], v[94:95] neg_lo:[0,1] neg_hi:[0,1]
    v_pk_fma_f32 v[96:97], v[98:99], v[98:99], v[96:97]
    v_pk_add_f32 v[98:99], v[28:29], v[94:95] neg_lo:[0,1] neg_hi:[0,1]
    v_pk_fma_f32 v[96:97], v[98:99], v[98:99], v[96:97]
    v_pk_add_f32 v[98:99], v[30:31], v[94:95] neg_lo:[0,1] neg_hi:[0,1]
    v_pk_fma_f32 v[96:97], v[98:99], v[98:99], v[96:97]
    v_pk_add_f32 v[98:99], v[32:33], v[94:95] neg_lo:[0,1] neg_hi:[0,1]
    v_pk_fma_f32 v[96:97], v[98:99], v[98:99], v[96:97]
    v_pk_add_f32 v[98:99], v[34:35], v[94:95] neg_lo:[0,1] neg_hi:[0,1]
    v_pk_fma_f32 v[96:97], v[98:99], v[98:99], v[96:97]
    v_add_f32 v96, v96, v97
    s_nop 1
    v_add_f32_dpp v98, v96, v96 quad_perm:[1,0,3,2] row_mask:0xf bank_mask:0xf
    s_nop 1
    v_add_f32_dpp v96, v98, v98 quad_perm:[2,3,0,1] row_mask:0xf bank_mask:0xf
    s_nop 1
    v_add_f32_dpp v98, v96, v96 row_half_mirror row_mask:0xf bank_mask:0xf
    s_nop 1
    v_add_f32_dpp v96, v98, v98 row_mirror row_mask:0xf bank_mask:0xf
    s_nop 1
    v_readlane_b32 s24, v96, 0
    v_readlane_b32 s25, v96, 16
    v_readlane_b32 s26, v96, 32
    v_readlane_b32 s27, v96, 48
    s_nop 1
    v_mov_b32 v96, s24
    v_add_f32 v96, s25, v96
    v_add_f32 v96, s26, v96
    v_add_f32 v96, s27, v96
    v_mul_f32 v96, 0x3a800000, v96
    v_cvt_pk_bf16_f32 v94, v94, v94
    v_lshlrev_b32 v94, 16, v94
    v_mov_b32 v95, v94
    v_cvt_pk_bf16_f32 v96, v96, v96
    v_lshlrev_b32 v96, 16, v96
    v_add_f32 v96, s19, v96
    v_cvt_pk_bf16_f32 v96, v96, v96
    v_lshlrev_b32 v96, 16, v96
    v_sqrt_f32 v96, v96
    s_nop 0
    v_cvt_pk_bf16_f32 v96, v96, v96
    v_lshlrev_b32 v96, 16, v96
    v_rcp_f32 v99, v96
    v_mov_b32 v97, v96
    v_mov_b32 v98, v99
    v_pk_add_f32 v[20:21], v[20:21], v[94:95] neg_lo:[0,1] neg_hi:[0,1]
    v_cvt_pk_bf16_f32 v20, v20, v21
    v_and_b32 v21, 0xffff0000, v20
    v_lshlrev_b32 v20, 16, v20
    v_pk_mul_f32 v[100:101], v[20:21], v[98:99]
    v_pk_fma_f32 v[102:103], v[100:101], v[96:97], v[20:21] neg_lo:[1,0,0] neg_hi:[1,0,0]
    v_pk_fma_f32 v[20:21], v[102:103], v[98:99], v[100:101]
    v_pk_add_f32 v[22:23], v[22:23], v[94:95] neg_lo:[0,1] neg_hi:[0,1]
    v_cvt_pk_bf16_f32 v22, v22, v23
    v_and_b32 v23, 0xffff0000, v22
    v_lshlrev_b32 v22, 16, v22
    v_pk_mul_f32 v[100:101], v[22:23], v[98:99]
    v_pk_fma_f32 v[102:103], v[100:101], v[96:97], v[22:23] neg_lo:[1,0,0] neg_hi:[1,0,0]
    v_pk_fma_f32 v[22:23], v[102:103], v[98:99], v[100:101]
    v_pk_add_f32 v[24:25], v[24:25], v[94:95] neg_lo:[0,1] neg_hi:[0,1]
    v_cvt_pk_bf16_f32 v24, v24, v25
    v_and_b32 v25, 0xffff0000, v24
    v_lshlrev_b32 v24, 16, v24
    v_pk_mul_f32 v[100:101], v[24:25], v[98:99]
    v_pk_fma_f32 v[102:103], v[100:101], v[96:97], v[24:25] neg_lo:[1,0,0] neg_hi:[1,0,0]
    v_pk_fma_f32 v[24:25], v[102:103], v[98:99], v[100:101]
    v_pk_add_f32 v[26:27], v[26:27], v[94:95] neg_lo:[0,1] neg_hi:[0,1]
    v_cvt_pk_bf16_f32 v26, v26, v27
    v_and_b32 v27, 0xffff0000, v26
    v_lshlrev_b32 v26, 16, v26
    v_pk_mul_f32 v[100:101], v[26:27], v[98:99]
    v_pk_fma_f32 v[102:103], v[100:101], v[96:97], v[26:27] neg_lo:[1,0,0] neg_hi:[1,0,0]
    v_pk_fma_f32 v[26:27], v[102:103], v[98:99], v[100:101]
    v_pk_add_f32 v[28:29], v[28:29], v[94:95] neg_lo:[0,1] neg_hi:[0,1]
    v_cvt_pk_bf16_f32 v28, v28, v29
    v_and_b32 v29, 0xffff0000, v28
    v_lshlrev_b32 v28, 16, v28
    v_pk_mul_f32 v[100:101], v[28:29], v[98:99]
    v_pk_fma_f32 v[102:103], v[100:101], v[96:97], v[28:29] neg_lo:[1,0,0] neg_hi:[1,0,0]
    v_pk_fma_f32 v[28:29], v[102:103], v[98:99], v[100:101]
    v_pk_add_f32 v[30:31], v[30:31], v[94:95] neg_lo:[0,1] neg_hi:[0,1]
    v_cvt_pk_bf16_f32 v30, v30, v31
    v_and_b32 v31, 0xffff0000, v30
    v_lshlrev_b32 v30, 16, v30
    v_pk_mul_f32 v[100:101], v[30:31], v[98:99]
    v_pk_fma_f32 v[102:103], v[100:101], v[96:97], v[30:31] neg_lo:[1,0,0] neg_hi:[1,0,0]
    v_pk_fma_f32 v[30:31], v[102:103], v[98:99], v[100:101]
    v_pk_add_f32 v[32:33], v[32:33], v[94:95] neg_lo:[0,1] neg_hi:[0,1]
    v_cvt_pk_bf16_f32 v32, v32, v33
    v_and_b32 v33, 0xffff0000, v32
    v_lshlrev_b32 v32, 16, v32
    v_pk_mul_f32 v[100:101], v[32:33], v[98:99]
    v_pk_fma_f32 v[102:103], v[100:101], v[96:97], v[32:33] neg_lo:[1,0,0] neg_hi:[1,0,0]
    v_pk_fma_f32 v[32:33], v[102:103], v[98:99], v[100:101]
    v_pk_add_f32 v[34:35], v[34:35], v[94:95] neg_lo:[0,1] neg_hi:[0,1]
    v_cvt_pk_bf16_f32 v34, v34, v35
    v_and_b32 v35, 0xffff0000, v34
    v_lshlrev_b32 v34, 16, v34
    v_pk_mul_f32 v[100:101], v[34:35], v[98:99]
    v_pk_fma_f32 v[102:103], v[100:101], v[96:97], v[34:35] neg_lo:[1,0,0] neg_hi:[1,0,0]
    v_pk_fma_f32 v[34:35], v[102:103], v[98:99], v[100:101]
    v_cvt_pk_bf16_f32 v20, v20, v21
    v_and_b32 v21, 0xffff0000, v20
    v_lshlrev_b32 v20, 16, v20
    v_cvt_pk_bf16_f32 v22, v22, v23
    v_and_b32 v23, 0xffff0000, v22
    v_lshlrev_b32 v22, 16, v22
    v_cvt_pk_bf16_f32 v24, v24, v25
    v_and_b32 v25, 0xffff0000, v24
    v_lshlrev_b32 v24, 16, v24
    v_cvt_pk_bf16_f32 v26, v26, v27
    v_and_b32 v27, 0xffff0000, v26
    v_lshlrev_b32 v26, 16, v26
    v_cvt_pk_bf16_f32 v28, v28, v29
    v_and_b32 v29, 0xffff0000, v28
    v_lshlrev_b32 v28, 16, v28
    v_cvt_pk_bf16_f32 v30, v30, v31
    v_and_b32 v31, 0xffff0000, v30
    v_lshlrev_b32 v30, 16, v30
    v_cvt_pk_bf16_f32 v32, v32, v33
    v_and_b32 v33, 0xffff0000, v32
    v_lshlrev_b32 v32, 16, v32
    v_cvt_pk_bf16_f32 v34, v34, v35
    v_and_b32 v35, 0xffff0000, v34
    v_lshlrev_b32 v34, 16, v34
    s_mov_b32 s20, 0
    s_mov_b32 s22, 0xbe000000
K1_PASS:
    v_lshlrev_b32 v5, s20, 1
    v_add_u32 v5, -1, v5
    v_and_b32 v6, v1, v5
    v_lshrrev_b32 v7, s20, v1
    s_add_u32 s21, s20, 3
    v_lshlrev_b32 v7, s21, v7
    v_add_u32 v7, v7, v6
    v_lshl_add_u32 v7, v7, 3, v4
    v_cvt_f32_u32 v6, v6
    v_mul_f32 v6, s22, v6
    v_cos_f32 v80, v6
    v_sin_f32 v81, v6
    v_mul_f32 v99, 2.0, v6
    v_cos_f32 v82, v99
    v_sin_f32 v83, v99
    v_mul_f32 v98, 0x40400000, v6
    v_cos_f32 v84, v98
    v_sin_f32 v85, v98
    v_mul_f32 v99, 4.0, v6
    v_cos_f32 v86, v99
    v_sin_f32 v87, v99
    v_mul_f32 v98, 0x40a00000, v6
    v_cos_f32 v88, v98
    v_sin_f32 v89, v98
    v_mul_f32 v99, 0x40c00000, v6
    v_cos_f32 v90, v99
    v_sin_f32 v91, v99
    v_mul_f32 v98, 0x40e00000, v6
    v_cos_f32 v92, v98
    v_sin_f32 v93, v98
    s_lshl_b32 s23, 8, s20
    v_pk_mul_f32 v[94:95], v[22:23], v[80:81] op_sel:[0,0] op_sel_hi:[1,0]
    v_pk_fma_f32 v[22:23], v[22:23], v[80:81], v[94:95] op_sel:[1,1,0] op_sel_hi:[0,1,1] neg_lo:[1,0,0]
    v_pk_mul_f32 v[94:95], v[24:25], v[82:83] op_sel:[0,0] op_sel_hi:[1,0]
    v_pk_fma_f32 v[24:25], v[24:25], v[82:83], v[94:95] op_sel:[1,1,0] op_sel_hi:[0,1,1] neg_lo:[1,0,0]
    v_pk_mul_f32 v[94:95], v[26:27], v[84:85] op_sel:[0,0] op_sel_hi:[1,0]
    v_pk_fma_f32 v[26:27], v[26:27], v[84:85], v[94:95] op_sel:[1,1,0] op_sel_hi:[0,1,1] neg_lo:[1,0,0]
    v_pk_mul_f32 v[94:95], v[28:29], v[86:87] op_sel:[0,0] op_sel_hi:[1,0]
    v_pk_fma_f32 v[28:29], v[28:29], v[86:87], v[94:95] op_sel:[1,1,0] op_sel_hi:[0,1,1] neg_lo:[1,0,0]
    v_pk_mul_f32 v[94:95], v[30:31], v[88:89] op_sel:[0,0] op_sel_hi:[1,0]
    v_pk_fma_f32 v[30:31], v[30:31], v[88:89], v[94:95] op_sel:[1,1,0] op_sel_hi:[0,1,1] neg_lo:[1,0,0]
    v_pk_mul_f32 v[94:95], v[32:33], v[90:91] op_sel:[0,0] op_sel_hi:[1,0]
    v_pk_fma_f32 v[32:33], v[32:33], v[90:91], v[94:95] op_sel:[1,1,0] op_sel_hi:[0,1,1] neg_lo:[1,0,0]
    v_pk_mul_f32 v[94:95], v[34:35], v[92:93] op_sel:[0,0] op_sel_hi:[1,0]
    v_pk_fma_f32 v[34:35], v[34:35], v[92:93], v[94:95] op_sel:[1,1,0] op_sel_hi:[0,1,1] neg_lo:[1,0,0]
    v_pk_add_f32 v[52:53], v[20:21], v[28:29]
    v_pk_add_f32 v[60:61], v[20:21], v[28:29] neg_lo:[0,1] neg_hi:[0,1]
    v_pk_add_f32 v[54:55], v[22:23], v[30:31]
    v_pk_add_f32 v[62:63], v[22:23], v[30:31] neg_lo:[0,1] neg_hi:[0,1]
    v_pk_add_f32 v[56:57], v[24:25], v[32:33]
    v_pk_add_f32 v[64:65], v[24:25], v[32:33] neg_lo:[0,1] neg_hi:[0,1]
    v_pk_add_f32 v[58:59], v[26:27], v[34:35]
    v_pk_add_f32 v[66:67], v[26:27], v[34:35] neg_lo:[0,1] neg_hi:[0,1]
    v_pk_add_f32 v[72:73], v[52:53], v[56:57]
    v_pk_add_f32 v[76:77], v[52:53], v[56:57] neg_lo:[0,1] neg_hi:[0,1]
    v_pk_add_f32 v[74:75], v[54:55], v[58:59]
    v_pk_add_f32 v[78:79], v[54:55], v[58:59] neg_lo:[0,1] neg_hi:[0,1]
    v_pk_add_f32 v[36:37], v[72:73], v[74:75]
    v_pk_add_f32 v[44:45], v[72:73], v[74:75] neg_lo:[0,1] neg_hi:[0,1]
    v_pk_add_f32 v[40:41], v[76:77], v[78:79] op_sel:[0,1] op_sel_hi:[1,0] neg_hi:[0,1]
    v_pk_add_f32 v[48:49], v[76:77], v[78:79] op_sel:[0,1] op_sel_hi:[1,0] neg_lo:[0,1]
    v_pk_add_f32 v[68:69], v[62:63], v[62:63] op_sel:[0,1] op_sel_hi:[1,0] neg_hi:[0,1]
    v_pk_mul_f32 v[68:69], v[68:69], s[16:17]
    v_pk_add_f32 v[70:71], v[66:67], v[66:67] op_sel:[0,1] op_sel_hi:[1,0] neg_hi:[0,1]
    v_pk_mul_f32 v[70:71], v[70:71], s[16:17]
    v_pk_add_f32 v[72:73], v[60:61], v[64:65] op_sel:[0,1] op_sel_hi:[1,0] neg_hi:[0,1]
    v_pk_add_f32 v[76:77], v[60:61], v[64:65] op_sel:[0,1] op_sel_hi:[1,0] neg_lo:[0,1]
    v_pk_add_f32 v[74:75], v[68:69], v[70:71] op_sel:[0,1] op_sel_hi:[1,0] neg_hi:[0,1]
    v_pk_add_f32 v[78:79], v[68:69], v[70:71] op_sel:[0,1] op_sel_hi:[1,0] neg_lo:[0,1]
    v_pk_add_f32 v[38:39], v[72:73], v[74:75]
    v_pk_add_f32 v[46:47], v[72:73], v[74:75] neg_lo:[0,1] neg_hi:[0,1]
    v_pk_add_f32 v[42:43], v[76:77], v[78:79] op_sel:[0,1] op_sel_hi:[1,0] neg_hi:[0,1]
    v_pk_add_f32 v[50:51], v[76:77], v[78:79] op_sel:[0,1] op_sel_hi:[1,0] neg_lo:[0,1]
    ds_write_b64 v7, v[36:37]
    v_add_u32 v7, s23, v7
    ds_write_b64 v7, v[38:39]
    v_add_u32 v7, s23, v7
    ds_write_b64 v7, v[40:41]
    v_add_u32 v7, s23, v7
    ds_write_b64 v7, v[42:43]
    v_add_u32 v7, s23, v7
    ds_write_b64 v7, v[44:45]
    v_add_u32 v7, s23, v7
    ds_write_b64 v7, v[46:47]
    v_add_u32 v7, s23, v7
    ds_write_b64 v7, v[48:49]
    v_add_u32 v7, s23, v7
    ds_write_b64 v7, v[50:51]
    s_cmp_eq_u32 s20, 6
    s_cbranch_scc1 K1_PASSDONE
    ds_read_b64 v[20:21], v3 offset:0
    ds_read_b64 v[22:23], v3 offset:512
    ds_read_b64 v[24:25], v3 offset:1024
    ds_read_b64 v[26:27], v3 offset:1536
    ds_read_b64 v[28:29], v3 offset:2048
    ds_read_b64 v[30:31], v3 offset:2560
    ds_read_b64 v[32:33], v3 offset:3072
    ds_read_b64 v[34:35], v3 offset:3584
    s_add_u32 s20, s20, 3
    s_sub_u32 s22, s22, 0x01800000
    s_waitcnt lgkmcnt(0)
    s_branch K1_PASS
K1_PASSDONE:
    s_waitcnt lgkmcnt(0)
    s_barrier
    v_and_b32 v2, 7, v0
    v_lshrrev_b32 v6, 3, v0
    v_mul_u32_u24 v4, 4128, v2
    s_lshl_b32 s18, s2, 6
    v_lshlrev_b32 v5, 3, v2
    v_add_u32 v5, s18, v5
    s_mov_b32 s20, 0
K1_POST:
    v_sub_u32 v7, 512, v6
    v_and_b32 v9, 511, v7
    v_lshl_add_u32 v8, v6, 3, v4
    v_lshl_add_u32 v9, v9, 3, v4
    ds_read_b64 v[20:21], v8
    ds_read_b64 v[22:23], v9
    v_cvt_f32_u32 v60, v6
    v_mul_f32 v60, 0xba800000, v60
    v_cos_f32 v62, v60
    v_sin_f32 v63, v60
    v_lshl_add_u32 v8, v6, 14, v5
    v_lshl_add_u32 v9, v7, 14, v5
    s_waitcnt lgkmcnt(0)
    v_pk_add_f32 v[50:51], v[20:21], v[22:23] neg_hi:[0,1]
    v_pk_add_f32 v[52:53], v[20:21], v[22:23] op_sel:[1,1] op_sel_hi:[0,0] neg_hi:[1,0]
    v_pk_mul_f32 v[56:57], v[52:53], v[62:63] op_sel:[0,0] op_sel_hi:[1,0]
    v_pk_fma_f32 v[54:55], v[52:53], v[62:63], v[56:57] op_sel:[1,1,0] op_sel_hi:[0,1,1] neg_lo:[1,0,0]
    v_pk_add_f32 v[56:57], v[50:51], v[54:55]
    v_pk_add_f32 v[58:59], v[50:51], v[54:55] neg_lo:[0,1] neg_hi:[1,0]
    buffer_store_dwordx2 v[56:57], v8, s[12:15], 0 offen
    buffer_store_dwordx2 v[58:59], v9, s[12:15], 0 offen
    v_add_u32 v6, 64, v6
    s_add_u32 s20, s20, 1
    s_cmp_lt_u32 s20, 4
    s_cbranch_scc1 K1_POST
    s_cmp_eq_u32 s20, 5
    s_cbranch_scc1 K1_END
    v_cmp_gt_u32 vcc, 8, v0
    s_and_saveexec_b64 s[28:29], vcc
    s_cbranch_execnz K1_POST
K1_END:
    s_endpgm
K1_WT:
    s_cmp_ge_u32 s2, 400
    s_cbranch_scc1 K1_PF
    s_load_dwordx4 s[4:7], s[0:1], 8
    s_load_dwordx2 s[28:29], s[0:1], 72
    s_sub_u32 s3, s2, 256
    s_lshr_b32 s18, s3, 4
    s_and_b32 s19, s3, 15
    v_and_b32 v1, 63, v0
    v_lshrrev_b32 v2, 6, v0
    s_lshl_b32 s20, s18, 7
    s_mul_i32 s21, s19, 128*1026
    s_add_u32 s20, s20, s21
    v_mul_u32_u24 v3, 16*1026, v2
    v_lshl_add_u32 v3, v1, 1, v3
    s_waitcnt lgkmcnt(0)
    s_mov_b32 s8, s4
    s_and_b32 s9, s5, 0xffff
    s_mov_b32 s10, 0x201000
    s_mov_b32 s11, 0x00020000
    s_mov_b32 s32, s6
    s_and_b32 s33, s7, 0xffff
    s_mov_b32 s34, 0x201000
    s_mov_b32 s35, 0x00020000
    s_add_u32 s12, s28, 0x900000
    s_addc_u32 s13, s29, 0x0
    s_and_b32 s13, s13, 0xffff
    s_mov_b32 s14, 0x402000
    s_mov_b32 s15, 0x00020000
    s_add_u32 s22, s20, 0
    buffer_load_ushort v20, v3, s[8:11], s22 offen
    buffer_load_ushort v40, v3, s[32:35], s22 offen
    s_add_u32 s22, s20, 1026
    buffer_load_ushort v21, v3, s[8:11], s22 offen
    buffer_load_ushort v41, v3, s[32:35], s22 offen
    s_add_u32 s22, s20, 2052
    buffer_load_ushort v22, v3, s[8:11], s22 offen
    buffer_load_ushort v42, v3, s[32:35], s22 offen
    s_add_u32 s22, s20, 3078
    buffer_load_ushort v23, v3, s[8:11], s22 offen
    buffer_load_ushort v43, v3, s[32:35], s22 offen
    s_add_u32 s22, s20, 4104
    buffer_load_ushort v24, v3, s[8:11], s22 offen
    buffer_load_ushort v44, v3, s[32:35], s22 offen
    s_add_u32 s22, s20, 5130
    buffer_load_ushort v25, v3, s[8:11], s22 offen
    buffer_load_ushort v45, v3, s[32:35], s22 offen
    s_add_u32 s22, s20, 6156
    buffer_load_ushort v26, v3, s[8:11], s22 offen
    buffer_load_ushort v46, v3, s[32:35], s22 offen
    s_add_u32 s22, s20, 7182
    buffer_load_ushort v27, v3, s[8:11], s22 offen
    buffer_load_ushort v47, v3, s[32:35], s22 offen
    s_add_u32 s22, s20, 8208
    buffer_load_ushort v28, v3, s[8:11], s22 offen
    buffer_load_ushort v48, v3, s[32:35], s22 offen
    s_add_u32 s22, s20, 9234
    buffer_load_ushort v29, v3, s[8:11], s22 offen
    buffer_load_ushort v49, v3, s[32:35], s22 offen
    s_add_u32 s22, s20, 10260
    buffer_load_ushort v30, v3, s[8:11], s22 offen
    buffer_load_ushort v50, v3, s[32:35], s22 offen
    s_add_u32 s22, s20, 11286
    buffer_load_ushort v31, v3, s[8:11], s22 offen
    buffer_load_ushort v51, v3, s[32:35], s22 offen
    s_add_u32 s22, s20, 12312
    buffer_load_ushort v32, v3, s[8:11], s22 offen
    buffer_load_ushort v52, v3, s[32:35], s22 offen
    s_add_u32 s22, s20, 13338
    buffer_load_ushort v33, v3, s[8:11], s22 offen
    buffer_load_ushort v53, v3, s[32:35], s22 offen
    s_add_u32 s22, s20, 14364
    buffer_load_ushort v34, v3, s[8:11], s22 offen
    buffer_load_ushort v54, v3, s[32:35], s22 offen
    s_add_u32 s22, s20, 15390
    buffer_load_ushort v35, v3, s[8:11], s22 offen
    buffer_load_ushort v55, v3, s[32:35], s22 offen
    v_mul_u32_u24 v4, 520, v1
    v_lshl_add_u32 v4, v2, 6, v4
    s_waitcnt vmcnt(0)
    v_lshl_or_b32 v20, v40, 16, v20
    ds_write_b32 v4, v20 offset:0
    v_lshl_or_b32 v21, v41, 16, v21
    ds_write_b32 v4, v21 offset:4
    v_lshl_or_b32 v22, v42, 16, v22
    ds_write_b32 v4, v22 offset:8
    v_lshl_or_b32 v23, v43, 16, v23
    ds_write_b32 v4, v23 offset:12
    v_lshl_or_b32 v24, v44, 16, v24
    ds_write_b32 v4, v24 offset:16
    v_lshl_or_b32 v25, v45, 16, v25
    ds_write_b32 v4, v25 offset:20
    v_lshl_or_b32 v26, v46, 16, v26
    ds_write_b32 v4, v26 offset:24
    v_lshl_or_b32 v27, v47, 16, v27
    ds_write_b32 v4, v27 offset:28
    v_lshl_or_b32 v28, v48, 16, v28
    ds_write_b32 v4, v28 offset:32
    v_lshl_or_b32 v29, v49, 16, v29
    ds_write_b32 v4, v29 offset:36
    v_lshl_or_b32 v30, v50, 16, v30
    ds_write_b32 v4, v30 offset:40
    v_lshl_or_b32 v31, v51, 16, v31
    ds_write_b32 v4, v31 offset:44
    v_lshl_or_b32 v32, v52, 16, v32
    ds_write_b32 v4, v32 offset:48
    v_lshl_or_b32 v33, v53, 16, v33
    ds_write_b32 v4, v33 offset:52
    v_lshl_or_b32 v34, v54, 16, v34
    ds_write_b32 v4, v34 offset:56
    v_lshl_or_b32 v35, v55, 16, v35
    ds_write_b32 v4, v35 offset:60
    s_waitcnt lgkmcnt(0)
    s_barrier
    v_mul_u32_u24 v4, 8*520, v2
    v_lshl_add_u32 v4, v1, 3, v4
    v_lshlrev_b32 v5, 16, v2
    v_lshl_add_u32 v5, v1, 3, v5
    s_lshl_b32 s20, s18, 19
    s_lshl_b32 s21, s19, 9
    s_add_u32 s20, s20, s21
    ds_read_b64 v[20:21], v4 offset:0
    ds_read_b64 v[22:23], v4 offset:520
    ds_read_b64 v[24:25], v4 offset:1040
    ds_read_b64 v[26:27], v4 offset:1560
    ds_read_b64 v[28:29], v4 offset:2080
    ds_read_b64 v[30:31], v4 offset:2600
    ds_read_b64 v[32:33], v4 offset:3120
    ds_read_b64 v[34:35], v4 offset:3640
    s_waitcnt lgkmcnt(0)
    s_add_u32 s22, s20, 0
    buffer_store_dwordx2 v[20:21], v5, s[12:15], s22 offen
    s_add_u32 s22, s20, 8192
    buffer_store_dwordx2 v[22:23], v5, s[12:15], s22 offen
    s_add_u32 s22, s20, 16384
    buffer_store_dwordx2 v[24:25], v5, s[12:15], s22 offen
    s_add_u32 s22, s20, 24576
    buffer_store_dwordx2 v[26:27], v5, s[12:15], s22 offen
    s_add_u32 s22, s20, 32768
    buffer_store_dwordx2 v[28:29], v5, s[12:15], s22 offen
    s_add_u32 s22, s20, 40960
    buffer_store_dwordx2 v[30:31], v5, s[12:15], s22 offen
    s_add_u32 s22, s20, 49152
    buffer_store_dwordx2 v[32:33], v5, s[12:15], s22 offen
    s_add_u32 s22, s20, 57344
    buffer_store_dwordx2 v[34:35], v5, s[12:15], s22 offen
    s_endpgm
K1_PF:
    s_cmp_ge_u32 s2, 416
    s_cbranch_scc1 K1_PFEND
    s_and_b32 s17, s2, 7
    s_sub_u32 s2, s2, 400
    s_lshr_b32 s3, s2, 3
    v_lshrrev_b32 v5, 8, v0
    s_nop 0
    v_readfirstlane_b32 s26, v5
    v_and_b32 v0, 255, v0
    s_lshl_b32 s3, s3, 1
    s_add_u32 s3, s3, s26
    s_add_u32 s3, s3, 0
    s_load_dwordx4 s[4:7], s[0:1], 32
    s_load_dwordx2 s[24:25], s[0:1], 48
    s_lshr_b32 s18, s17, 1
    s_mul_i32 s18, s18, 1792
    s_mul_i32 s19, s3, 16*7168
    s_add_u32 s18, s18, s19
    v_cmp_gt_u32 vcc, 112, v0
    v_mov_b32 v2, 7168-1792
    s_nop 0
    v_cndmask_b32 v2, v2, 0, vcc
    v_lshl_add_u32 v1, v0, 4, v2
    s_mul_i32 s19, s3, 56
    s_and_b32 s20, s17, 3
    s_mul_i32 s20, s20, 14
    s_add_u32 s19, s19, s20
    s_lshl_b32 s19, s19, 11
    s_lshr_b32 s20, s17, 2
    s_lshl_b32 s20, s20, 10
    s_add_u32 s19, s19, s20
    v_lshrrev_b32 v3, 6, v0
    v_and_b32 v4, 63, v0
    v_lshlrev_b32 v4, 4, v4
    v_lshl_add_u32 v3, v3, 11, v4
    s_waitcnt lgkmcnt(0)
    s_mov_b32 s8, s4
    s_and_b32 s9, s5, 0xffff
    s_mov_b32 s10, 0x700000
    s_mov_b32 s11, 0x00020000
    s_mov_b32 s12, s6
    s_and_b32 s13, s7, 0xffff
    s_mov_b32 s14, 0x700000
    s_mov_b32 s15, 0x00020000
    s_mov_b32 s28, s24
    s_and_b32 s29, s25, 0xffff
    s_mov_b32 s30, 0x700000
    s_mov_b32 s31, 0x00020000
    s_add_u32 s23, s19, 0
    buffer_load_dwordx4 v[80:83], v3, s[28:31], s23 offen
    s_add_u32 s23, s19, 8192
    buffer_load_dwordx4 v[84:87], v3, s[28:31], s23 offen
    s_add_u32 s23, s19, 16384
    buffer_load_dwordx4 v[88:91], v3, s[28:31], s23 offen
    s_add_u32 s23, s19, 24576
    buffer_load_dwordx4 v[92:95], v3, s[28:31], s23 offen
    v_cmp_gt_u32 vcc, 224, v0
    s_and_saveexec_b64 s[20:21], vcc
    s_cbranch_execz K1_PFEND
    s_add_u32 s23, s18, 0
    buffer_load_dwordx4 v[8:11], v1, s[8:11], s23 offen
    buffer_load_dwordx4 v[12:15], v1, s[12:15], s23 offen
    s_add_u32 s23, s18, 14336
    buffer_load_dwordx4 v[16:19], v1, s[8:11], s23 offen
    buffer_load_dwordx4 v[20:23], v1, s[12:15], s23 offen
    s_add_u32 s23, s18, 28672
    buffer_load_dwordx4 v[24:27], v1, s[8:11], s23 offen
    buffer_load_dwordx4 v[28:31], v1, s[12:15], s23 offen
    s_add_u32 s23, s18, 43008
    buffer_load_dwordx4 v[32:35], v1, s[8:11], s23 offen
    buffer_load_dwordx4 v[36:39], v1, s[12:15], s23 offen
    s_add_u32 s23, s18, 57344
    buffer_load_dwordx4 v[40:43], v1, s[8:11], s23 offen
    buffer_load_dwordx4 v[44:47], v1, s[12:15], s23 offen
    s_add_u32 s23, s18, 71680
    buffer_load_dwordx4 v[48:51], v1, s[8:11], s23 offen
    buffer_load_dwordx4 v[52:55], v1, s[12:15], s23 offen
    s_add_u32 s23, s18, 86016
    buffer_load_dwordx4 v[56:59], v1, s[8:11], s23 offen
    buffer_load_dwordx4 v[60:63], v1, s[12:15], s23 offen
    s_add_u32 s23, s18, 100352
    buffer_load_dwordx4 v[64:67], v1, s[8:11], s23 offen
    buffer_load_dwordx4 v[68:71], v1, s[12:15], s23 offen
K1_PFEND:
    s_endpgm
.globl k2_kernel
.p2align 8
.type k2_kernel,@function
k2_kernel:
    s_cmp_ge_u32 s2, 513
    s_cbranch_scc1 K2_PF
    s_load_dwordx2 s[28:29], s[0:1], 72
    v_lshlrev_b32 v1, 3, v0
    s_lshl_b32 s30, s2, 14
    v_lshlrev_b32 v2, 2, v0
    s_lshl_b32 s18, s2, 13
    s_waitcnt lgkmcnt(0)
    s_mov_b32 s12, s28
    s_and_b32 s13, s29, 0xffff
    s_mov_b32 s14, 0x804000
    s_mov_b32 s15, 0x00020000
    s_add_u32 s40, s30, 0
    buffer_load_dwordx2 v[20:21], v1, s[12:15], s40 offen
    s_add_u32 s41, s30, 2048
    buffer_load_dwordx2 v[22:23], v1, s[12:15], s41 offen
    s_add_u32 s42, s30, 4096
    buffer_load_dwordx2 v[24:25], v1, s[12:15], s42 offen
    s_add_u32 s43, s30, 6144
    buffer_load_dwordx2 v[26:27], v1, s[12:15], s43 offen
    s_add_u32 s44, s30, 8192
    buffer_load_dwordx2 v[28:29], v1, s[12:15], s44 offen
    s_add_u32 s45, s30, 10240
    buffer_load_dwordx2 v[30:31], v1, s[12:15], s45 offen
    s_add_u32 s46, s30, 12288
    buffer_load_dwordx2 v[32:33], v1, s[12:15], s46 offen
    s_add_u32 s47, s30, 14336
    buffer_load_dwordx2 v[34:35], v1, s[12:15], s47 offen
    s_add_u32 s8, s28, 0x900000
    s_addc_u32 s9, s29, 0x0
    s_and_b32 s9, s9, 0xffff
    s_mov_b32 s10, 0x402000
    s_mov_b32 s11, 0x00020000
    buffer_load_dword v104, v2, s[8:11], s18 offen offset:0
    buffer_load_dword v106, v2, s[8:11], s18 offen offset:1024
    buffer_load_dword v108, v2, s[8:11], s18 offen offset:2048
    buffer_load_dword v110, v2, s[8:11], s18 offen offset:3072
    s_add_u32 s31, s18, 4096
    buffer_load_dword v112, v2, s[8:11], s31 offen
    s_add_u32 s31, s18, 5120
    buffer_load_dword v114, v2, s[8:11], s31 offen
    s_add_u32 s31, s18, 6144
    buffer_load_dword v116, v2, s[8:11], s31 offen
    s_add_u32 s31, s18, 7168
    buffer_load_dword v118, v2, s[8:11], s31 offen
    s_mov_b32 s16, 0x3f3504f3
    s_mov_b32 s17, 0x3f3504f3
    s_mov_b32 s36, 0x34800000
    s_mov_b32 s37, 0xb4800000
    s_mov_b32 s38, 0
    v_mov_b32 v4, 0
    v_mov_b32 v3, v1
    s_waitcnt vmcnt(8)
K2_FFT:
    s_mov_b32 s20, 0
    s_mov_b32 s22, 0xbe000000
K2_PASS:
    v_lshlrev_b32 v5, s20, 1
    v_add_u32 v5, -1, v5
    v_and_b32 v6, v0, v5
    v_lshrrev_b32 v7, s20, v0
    s_add_u32 s21, s20, 3
    v_lshlrev_b32 v7, s21, v7
    v_add_u32 v7, v7, v6
    v_lshl_add_u32 v7, v7, 3, v4
    v_cvt_f32_u32 v6, v6
    v_mul_f32 v6, s22, v6
    v_cos_f32 v80, v6
    v_sin_f32 v81, v6
    v_mul_f32 v99, 2.0, v6
    v_cos_f32 v82, v99
    v_sin_f32 v83, v99
    v_mul_f32 v98, 0x40400000, v6
    v_cos_f32 v84, v98
    v_sin_f32 v85, v98
    v_mul_f32 v99, 4.0, v6
    v_cos_f32 v86, v99
    v_sin_f32 v87, v99
    v_mul_f32 v98, 0x40a00000, v6
    v_cos_f32 v88, v98
    v_sin_f32 v89, v98
    v_mul_f32 v99, 0x40c00000, v6
    v_cos_f32 v90, v99
    v_sin_f32 v91, v99
    v_mul_f32 v98, 0x40e00000, v6
    v_cos_f32 v92, v98
    v_sin_f32 v93, v98
    s_lshl_b32 s23, 8, s20
    v_pk_mul_f32 v[94:95], v[22:23], v[80:81] op_sel:[0,0] op_sel_hi:[1,0]
    v_pk_fma_f32 v[22:23], v[22:23], v[80:81], v[94:95] op_sel:[1,1,0] op_sel_hi:[0,1,1] neg_lo:[1,0,0]
    v_pk_mul_f32 v[94:95], v[24:25], v[82:83] op_sel:[0,0] op_sel_hi:[1,0]
    v_pk_fma_f32 v[24:25], v[24:25], v[82:83], v[94:95] op_sel:[1,1,0] op_sel_hi:[0,1,1] neg_lo:[1,0,0]
    v_pk_mul_f32 v[94:95], v[26:27], v[84:85] op_sel:[0,0] op_sel_hi:[1,0]
    v_pk_fma_f32 v[26:27], v[26:27], v[84:85], v[94:95] op_sel:[1,1,0] op_sel_hi:[0,1,1] neg_lo:[1,0,0]
    v_pk_mul_f32 v[94:95], v[28:29], v[86:87] op_sel:[0,0] op_sel_hi:[1,0]
    v_pk_fma_f32 v[28:29], v[28:29], v[86:87], v[94:95] op_sel:[1,1,0] op_sel_hi:[0,1,1] neg_lo:[1,0,0]
    v_pk_mul_f32 v[94:95], v[30:31], v[88:89] op_sel:[0,0] op_sel_hi:[1,0]
    v_pk_fma_f32 v[30:31], v[30:31], v[88:89], v[94:95] op_sel:[1,1,0] op_sel_hi:[0,1,1] neg_lo:[1,0,0]
    v_pk_mul_f32 v[94:95], v[32:33], v[90:91] op_sel:[0,0] op_sel_hi:[1,0]
    v_pk_fma_f32 v[32:33], v[32:33], v[90:91], v[94:95] op_sel:[1,1,0] op_sel_hi:[0,1,1] neg_lo:[1,0,0]
    v_pk_mul_f32 v[94:95], v[34:35], v[92:93] op_sel:[0,0] op_sel_hi:[1,0]
    v_pk_fma_f32 v[34:35], v[34:35], v[92:93], v[94:95] op_sel:[1,1,0] op_sel_hi:[0,1,1] neg_lo:[1,0,0]
    v_pk_add_f32 v[52:53], v[20:21], v[28:29]
    v_pk_add_f32 v[60:61], v[20:21], v[28:29] neg_lo:[0,1] neg_hi:[0,1]
    v_pk_add_f32 v[54:55], v[22:23], v[30:31]
    v_pk_add_f32 v[62:63], v[22:23], v[30:31] neg_lo:[0,1] neg_hi:[0,1]
    v_pk_add_f32 v[56:57], v[24:25], v[32:33]
    v_pk_add_f32 v[64:65], v[24:25], v[32:33] neg_lo:[0,1] neg_hi:[0,1]
    v_pk_add_f32 v[58:59], v[26:27], v[34:35]
    v_pk_add_f32 v[66:67], v[26:27], v[34:35] neg_lo:[0,1] neg_hi:[0,1]
    v_pk_add_f32 v[72:73], v[52:53], v[56:57]
    v_pk_add_f32 v[76:77], v[52:53], v[56:57] neg_lo:[0,1] neg_hi:[0,1]
    v_pk_add_f32 v[74:75], v[54:55], v[58:59]
    v_pk_add_f32 v[78:79], v[54:55], v[58:59] neg_lo:[0,1] neg_hi:[0,1]
    v_pk_add_f32 v[36:37], v[72:73], v[74:75]
    v_pk_add_f32 v[44:45], v[72:73], v[74:75] neg_lo:[0,1] neg_hi:[0,1]
    v_pk_add_f32 v[40:41], v[76:77], v[78:79] op_sel:[0,1] op_sel_hi:[1,0] neg_hi:[0,1]
    v_pk_add_f32 v[48:49], v[76:77], v[78:79] op_sel:[0,1] op_sel_hi:[1,0] neg_lo:[0,1]
    v_pk_add_f32 v[68:69], v[62:63], v[62:63] op_sel:[0,1] op_sel_hi:[1,0] neg_hi:[0,1]
    v_pk_mul_f32 v[68:69], v[68:69], s[16:17]
    v_pk_add_f32 v[70:71], v[66:67], v[66:67] op_sel:[0,1] op_sel_hi:[1,0] neg_hi:[0,1]
    v_pk_mul_f32 v[70:71], v[70:71], s[16:17]
    v_pk_add_f32 v[72:73], v[60:61], v[64:65] op_sel:[0,1] op_sel_hi:[1,0] neg_hi:[0,1]
    v_pk_add_f32 v[76:77], v[60:61], v[64:65] op_sel:[0,1] op_sel_hi:[1,0] neg_lo:[0,1]
    v_pk_add_f32 v[74:75], v[68:69], v[70:71] op_sel:[0,1] op_sel_hi:[1,0] neg_hi:[0,1]
    v_pk_add_f32 v[78:79], v[68:69], v[70:71] op_sel:[0,1] op_sel_hi:[1,0] neg_lo:[0,1]
    v_pk_add_f32 v[38:39], v[72:73], v[74:75]
    v_pk_add_f32 v[46:47], v[72:73], v[74:75] neg_lo:[0,1] neg_hi:[0,1]
    v_pk_add_f32 v[42:43], v[76:77], v[78:79] op_sel:[0,1] op_sel_hi:[1,0] neg_hi:[0,1]
    v_pk_add_f32 v[50:51], v[76:77], v[78:79] op_sel:[0,1] op_sel_hi:[1,0] neg_lo:[0,1]
    ds_write_b64 v7, v[36:37]
    v_add_u32 v7, s23, v7
    ds_write_b64 v7, v[38:39]
    v_add_u32 v7, s23, v7
    ds_write_b64 v7, v[40:41]
    v_add_u32 v7, s23, v7
    ds_write_b64 v7, v[42:43]
    v_add_u32 v7, s23, v7
    ds_write_b64 v7, v[44:45]
    v_add_u32 v7, s23, v7
    ds_write_b64 v7, v[46:47]
    v_add_u32 v7, s23, v7
    ds_write_b64 v7, v[48:49]
    v_add_u32 v7, s23, v7
    ds_write_b64 v7, v[50:51]
    s_waitcnt lgkmcnt(0)
    s_barrier
    ds_read_b64 v[20:21], v3 offset:0
    ds_read_b64 v[22:23], v3 offset:2048
    ds_read_b64 v[24:25], v3 offset:4096
    ds_read_b64 v[26:27], v3 offset:6144
    ds_read_b64 v[28:29], v3 offset:8192
    ds_read_b64 v[30:31], v3 offset:10240
    ds_read_b64 v[32:33], v3 offset:12288
    ds_read_b64 v[34:35], v3 offset:14336
    v_xor_b32 v3, 0x4000, v3
    v_xor_b32 v4, 0x4000, v4
    s_add_u32 s20, s20, 3
    s_sub_u32 s22, s22, 0x01800000
    s_cmp_lt_u32 s20, 9
    s_waitcnt lgkmcnt(0)
    s_cbranch_scc1 K2_PASS
    v_cvt_f32_u32 v6, v0
    v_mul_f32 v6, 0xba000000, v6
    v_cos_f32 v80, v6
    v_sin_f32 v81, v6
    v_mul_f32 v99, 2.0, v6
    v_cos_f32 v82, v99
    v_sin_f32 v83, v99
    v_mul_f32 v98, 0x40400000, v6
    v_cos_f32 v84, v98
    v_sin_f32 v85, v98
    v_add_f32 v6, 0xbe000000, v6
    v_cos_f32 v86, v6
    v_sin_f32 v87, v6
    v_mul_f32 v99, 2.0, v6
    v_cos_f32 v88, v99
    v_sin_f32 v89, v99
    v_mul_f32 v98, 0x40400000, v6
    v_cos_f32 v90, v98
    v_sin_f32 v91, v98
    v_pk_mul_f32 v[94:95], v[24:25], v[80:81] op_sel:[0,0] op_sel_hi:[1,0]
    v_pk_fma_f32 v[24:25], v[24:25], v[80:81], v[94:95] op_sel:[1,1,0] op_sel_hi:[0,1,1] neg_lo:[1,0,0]
    v_pk_mul_f32 v[94:95], v[28:29], v[82:83] op_sel:[0,0] op_sel_hi:[1,0]
    v_pk_fma_f32 v[28:29], v[28:29], v[82:83], v[94:95] op_sel:[1,1,0] op_sel_hi:[0,1,1] neg_lo:[1,0,0]
    v_pk_mul_f32 v[94:95], v[32:33], v[84:85] op_sel:[0,0] op_sel_hi:[1,0]
    v_pk_fma_f32 v[32:33], v[32:33], v[84:85], v[94:95] op_sel:[1,1,0] op_sel_hi:[0,1,1] neg_lo:[1,0,0]
    v_pk_add_f32 v[72:73], v[20:21], v[28:29]
    v_pk_add_f32 v[76:77], v[20:21], v[28:29] neg_lo:[0,1] neg_hi:[0,1]
    v_pk_add_f32 v[74:75], v[24:25], v[32:33]
    v_pk_add_f32 v[78:79], v[24:25], v[32:33] neg_lo:[0,1] neg_hi:[0,1]
    v_pk_add_f32 v[36:37], v[72:73], v[74:75]
    v_pk_add_f32 v[44:45], v[72:73], v[74:75] neg_lo:[0,1] neg_hi:[0,1]
    v_pk_add_f32 v[40:41], v[76:77], v[78:79] op_sel:[0,1] op_sel_hi:[1,0] neg_hi:[0,1]
    v_pk_add_f32 v[48:49], v[76:77], v[78:79] op_sel:[0,1] op_sel_hi:[1,0] neg_lo:[0,1]
    v_pk_mul_f32 v[94:95], v[26:27], v[86:87] op_sel:[0,0] op_sel_hi:[1,0]
    v_pk_fma_f32 v[26:27], v[26:27], v[86:87], v[94:95] op_sel:[1,1,0] op_sel_hi:[0,1,1] neg_lo:[1,0,0]
    v_pk_mul_f32 v[94:95], v[30:31], v[88:89] op_sel:[0,0] op_sel_hi:[1,0]
    v_pk_fma_f32 v[30:31], v[30:31], v[88:89], v[94:95] op_sel:[1,1,0] op_sel_hi:[0,1,1] neg_lo:[1,0,0]
    v_pk_mul_f32 v[94:95], v[34:35], v[90:91] op_sel:[0,0] op_sel_hi:[1,0]
    v_pk_fma_f32 v[34:35], v[34:35], v[90:91], v[94:95] op_sel:[1,1,0] op_sel_hi:[0,1,1] neg_lo:[1,0,0]
    v_pk_add_f32 v[72:73], v[22:23], v[30:31]
    v_pk_add_f32 v[76:77], v[22:23], v[30:31] neg_lo:[0,1] neg_hi:[0,1]
    v_pk_add_f32 v[74:75], v[26:27], v[34:35]
    v_pk_add_f32 v[78:79], v[26:27], v[34:35] neg_lo:[0,1] neg_hi:[0,1]
    v_pk_add_f32 v[38:39], v[72:73], v[74:75]
    v_pk_add_f32 v[46:47], v[72:73], v[74:75] neg_lo:[0,1] neg_hi:[0,1]
    v_pk_add_f32 v[42:43], v[76:77], v[78:79] op_sel:[0,1] op_sel_hi:[1,0] neg_hi:[0,1]
    v_pk_add_f32 v[50:51], v[76:77], v[78:79] op_sel:[0,1] op_sel_hi:[1,0] neg_lo:[0,1]
    s_cmp_eq_u32 s38, 1
    s_cbranch_scc1 K2_STORE
    s_waitcnt vmcnt(0)
    v_and_b32 v105, 0xffff0000, v104
    v_lshlrev_b32 v104, 16, v104
    v_pk_mul_f32 v[94:95], v[36:37], v[104:105] op_sel:[0,0] op_sel_hi:[1,0]
    v_pk_fma_f32 v[36:37], v[36:37], v[104:105], v[94:95] op_sel:[1,1,0] op_sel_hi:[0,1,1] neg_lo:[1,0,0]
    v_pk_mul_f32 v[20:21], v[36:37], s[36:37]
    v_and_b32 v107, 0xffff0000, v106
    v_lshlrev_b32 v106, 16, v106
    v_pk_mul_f32 v[94:95], v[38:39], v[106:107] op_sel:[0,0] op_sel_hi:[1,0]
    v_pk_fma_f32 v[38:39], v[38:39], v[106:107], v[94:95] op_sel:[1,1,0] op_sel_hi:[0,1,1] neg_lo:[1,0,0]
    v_pk_mul_f32 v[22:23], v[38:39], s[36:37]
    v_and_b32 v109, 0xffff0000, v108
    v_lshlrev_b32 v108, 16, v108
    v_pk_mul_f32 v[94:95], v[40:41], v[108:109] op_sel:[0,0] op_sel_hi:[1,0]
    v_pk_fma_f32 v[40:41], v[40:41], v[108:109], v[94:95] op_sel:[1,1,0] op_sel_hi:[0,1,1] neg_lo:[1,0,0]
    v_pk_mul_f32 v[24:25], v[40:41], s[36:37]
    v_and_b32 v111, 0xffff0000, v110
    v_lshlrev_b32 v110, 16, v110
    v_pk_mul_f32 v[94:95], v[42:43], v[110:111] op_sel:[0,0] op_sel_hi:[1,0]
    v_pk_fma_f32 v[42:43], v[42:43], v[110:111], v[94:95] op_sel:[1,1,0] op_sel_hi:[0,1,1] neg_lo:[1,0,0]
    v_pk_mul_f32 v[26:27], v[42:43], s[36:37]
    v_and_b32 v113, 0xffff0000, v112
    v_lshlrev_b32 v112, 16, v112
    v_pk_mul_f32 v[94:95], v[44:45], v[112:113] op_sel:[0,0] op_sel_hi:[1,0]
    v_pk_fma_f32 v[44:45], v[44:45], v[112:113], v[94:95] op_sel:[1,1,0] op_sel_hi:[0,1,1] neg_lo:[1,0,0]
    v_pk_mul_f32 v[28:29], v[44:45], s[36:37]
    v_and_b32 v115, 0xffff0000, v114
    v_lshlrev_b32 v114, 16, v114
    v_pk_mul_f32 v[94:95], v[46:47], v[114:115] op_sel:[0,0] op_sel_hi:[1,0]
    v_pk_fma_f32 v[46:47], v[46:47], v[114:115], v[94:95] op_sel:[1,1,0] op_sel_hi:[0,1,1] neg_lo:[1,0,0]
    v_pk_mul_f32 v[30:31], v[46:47], s[36:37]
    v_and_b32 v117, 0xffff0000, v116
    v_lshlrev_b32 v116, 16, v116
    v_pk_mul_f32 v[94:95], v[48:49], v[116:117] op_sel:[0,0] op_sel_hi:[1,0]
    v_pk_fma_f32 v[48:49], v[48:49], v[116:117], v[94:95] op_sel:[1,1,0] op_sel_hi:[0,1,1] neg_lo:[1,0,0]
    v_pk_mul_f32 v[32:33], v[48:49], s[36:37]
    v_and_b32 v119, 0xffff0000, v118
    v_lshlrev_b32 v118, 16, v118
    v_pk_mul_f32 v[94:95], v[50:51], v[118:119] op_sel:[0,0] op_sel_hi:[1,0]
    v_pk_fma_f32 v[50:51], v[50:51], v[118:119], v[94:95] op_sel:[1,1,0] op_sel_hi:[0,1,1] neg_lo:[1,0,0]
    v_pk_mul_f32 v[34:35], v[50:51], s[36:37]
    s_mov_b32 s38, 1
    s_branch K2_FFT
K2_STORE:
    buffer_store_dwordx2 v[36:37], v1, s[12:15], s40 offen
    buffer_store_dwordx2 v[38:39], v1, s[12:15], s41 offen
    buffer_store_dwordx2 v[40:41], v1, s[12:15], s42 offen
    buffer_store_dwordx2 v[42:43], v1, s[12:15], s43 offen
    buffer_store_dwordx2 v[44:45], v1, s[12:15], s44 offen
    buffer_store_dwordx2 v[46:47], v1, s[12:15], s45 offen
    buffer_store_dwordx2 v[48:49], v1, s[12:15], s46 offen
    buffer_store_dwordx2 v[50:51], v1, s[12:15], s47 offen
K2_END:
    s_endpgm
K2_PF:
    s_cmp_ge_u32 s2, 993
    s_cbranch_scc1 K2_PFEND
    s_and_b32 s17, s2, 7
    s_sub_u32 s2, s2, 513
    s_lshr_b32 s3, s2, 3
    s_add_u32 s3, s3, 4
    s_load_dwordx4 s[4:7], s[0:1], 32
    s_load_dwordx2 s[24:25], s[0:1], 48
    s_lshr_b32 s18, s17, 1
    s_mul_i32 s18, s18, 1792
    s_mul_i32 s19, s3, 16*7168
    s_add_u32 s18, s18, s19
    v_cmp_gt_u32 vcc, 112, v0
    v_mov_b32 v2, 7168-1792
    s_nop 0
    v_cndmask_b32 v2, v2, 0, vcc
    v_lshl_add_u32 v1, v0, 4, v2
    s_mul_i32 s19, s3, 56
    s_and_b32 s20, s17, 3
    s_mul_i32 s20, s20, 14
    s_add_u32 s19, s19, s20
    s_lshl_b32 s19, s19, 11
    s_lshr_b32 s20, s17, 2
    s_lshl_b32 s20, s20, 10
    s_add_u32 s19, s19, s20
    v_lshrrev_b32 v3, 6, v0
    v_and_b32 v4, 63, v0
    v_lshlrev_b32 v4, 4, v4
    v_lshl_add_u32 v3, v3, 11, v4
    s_waitcnt lgkmcnt(0)
    s_mov_b32 s8, s4
    s_and_b32 s9, s5, 0xffff
    s_mov_b32 s10, 0x700000
    s_mov_b32 s11, 0x00020000
    s_mov_b32 s12, s6
    s_and_b32 s13, s7, 0xffff
    s_mov_b32 s14, 0x700000
    s_mov_b32 s15, 0x00020000
    s_mov_b32 s28, s24
    s_and_b32 s29, s25, 0xffff
    s_mov_b32 s30, 0x700000
    s_mov_b32 s31, 0x00020000
    s_add_u32 s23, s19, 0
    buffer_load_dwordx4 v[80:83], v3, s[28:31], s23 offen
    s_add_u32 s23, s19, 8192
    buffer_load_dwordx4 v[84:87], v3, s[28:31], s23 offen
    s_add_u32 s23, s19, 16384
    buffer_load_dwordx4 v[88:91], v3, s[28:31], s23 offen
    s_add_u32 s23, s19, 24576
    buffer_load_dwordx4 v[92:95], v3, s[28:31], s23 offen
    v_cmp_gt_u32 vcc, 224, v0
    s_and_saveexec_b64 s[20:21], vcc
    s_cbranch_execz K2_PFEND
    s_add_u32 s23, s18, 0
    buffer_load_dwordx4 v[8:11], v1, s[8:11], s23 offen
    buffer_load_dwordx4 v[12:15], v1, s[12:15], s23 offen
    s_add_u32 s23, s18, 14336
    buffer_load_dwordx4 v[16:19], v1, s[8:11], s23 offen
    buffer_load_dwordx4 v[20:23], v1, s[12:15], s23 offen
    s_add_u32 s23, s18, 28672
    buffer_load_dwordx4 v[24:27], v1, s[8:11], s23 offen
    buffer_load_dwordx4 v[28:31], v1, s[12:15], s23 offen
    s_add_u32 s23, s18, 43008
    buffer_load_dwordx4 v[32:35], v1, s[8:11], s23 offen
    buffer_load_dwordx4 v[36:39], v1, s[12:15], s23 offen
    s_add_u32 s23, s18, 57344
    buffer_load_dwordx4 v[40:43], v1, s[8:11], s23 offen
    buffer_load_dwordx4 v[44:47], v1, s[12:15], s23 offen
    s_add_u32 s23, s18, 71680
    buffer_load_dwordx4 v[48:51], v1, s[8:11], s23 offen
    buffer_load_dwordx4 v[52:55], v1, s[12:15], s23 offen
    s_add_u32 s23, s18, 86016
    buffer_load_dwordx4 v[56:59], v1, s[8:11], s23 offen
    buffer_load_dwordx4 v[60:63], v1, s[12:15], s23 offen
    s_add_u32 s23, s18, 100352
    buffer_load_dwordx4 v[64:67], v1, s[8:11], s23 offen
    buffer_load_dwordx4 v[68:71], v1, s[12:15], s23 offen
K2_PFEND:
    s_endpgm
.globl k3_kernel
.p2align 8
.type k3_kernel,@function
k3_kernel:
    s_cmp_ge_u32 s2, 256
    s_cbranch_scc1 K3_PF
    s_load_dwordx2 s[4:5], s[0:1], 0
    s_load_dwordx2 s[6:7], s[0:1], 72
    s_load_dwordx2 s[28:29], s[0:1], 56
    v_and_b32 v1, 63, v0
    v_lshrrev_b32 v2, 6, v0
    v_and_b32 v10, 7, v0
    v_lshrrev_b32 v6, 3, v0
    v_mul_u32_u24 v12, 4128, v10
    s_lshl_b32 s18, s2, 6
    v_lshlrev_b32 v13, 3, v10
    v_add_u32 v13, s18, v13
    s_waitcnt lgkmcnt(0)
    s_mov_b32 s12, s6
    s_and_b32 s13, s7, 0xffff
    s_mov_b32 s14, 0x804000
    s_mov_b32 s15, 0x00020000
    v_add_u32 v7, 0, v6
    v_sub_u32 v8, 512, v7
    v_lshl_add_u32 v7, v7, 14, v13
    v_lshl_add_u32 v8, v8, 14, v13
    buffer_load_dwordx2 v[104:105], v7, s[12:15], 0 offen
    buffer_load_dwordx2 v[106:107], v8, s[12:15], 0 offen
    v_add_u32 v7, 64, v6
    v_sub_u32 v8, 512, v7
    v_lshl_add_u32 v7, v7, 14, v13
    v_lshl_add_u32 v8, v8, 14, v13
    buffer_load_dwordx2 v[108:109], v7, s[12:15], 0 offen
    buffer_load_dwordx2 v[110:111], v8, s[12:15], 0 offen
    v_add_u32 v7, 128, v6
    v_sub_u32 v8, 512, v7
    v_lshl_add_u32 v7, v7, 14, v13
    v_lshl_add_u32 v8, v8, 14, v13
    buffer_load_dwordx2 v[112:113], v7, s[12:15], 0 offen
    buffer_load_dwordx2 v[114:115], v8, s[12:15], 0 offen
    v_add_u32 v7, 192, v6
    v_sub_u32 v8, 512, v7
    v_lshl_add_u32 v7, v7, 14, v13
    v_lshl_add_u32 v8, v8, 14, v13
    buffer_load_dwordx2 v[116:117], v7, s[12:15], 0 offen
    buffer_load_dwordx2 v[118:119], v8, s[12:15], 0 offen
    v_add_u32 v7, 256, v6
    v_min_u32 v7, 256, v7
    v_sub_u32 v8, 512, v7
    v_lshl_add_u32 v7, v7, 14, v13
    v_lshl_add_u32 v8, v8, 14, v13
    buffer_load_dwordx2 v[120:121], v7, s[12:15], 0 offen
    buffer_load_dwordx2 v[122:123], v8, s[12:15], 0 offen
    s_mov_b32 s8, s4
    s_and_b32 s9, s5, 0xffff
    s_mov_b32 s10, 0x400000
    s_mov_b32 s11, 0x00020000
    s_lshl_b32 s31, s2, 14
    v_lshlrev_b32 v15, 11, v2
    v_lshl_add_u32 v15, v1, 2, v15
    buffer_load_dword v124, v15, s[8:11], s31 offen offset:0
    buffer_load_dword v125, v15, s[8:11], s31 offen offset:256
    buffer_load_dword v126, v15, s[8:11], s31 offen offset:512
    buffer_load_dword v127, v15, s[8:11], s31 offen offset:768
    buffer_load_dword v128, v15, s[8:11], s31 offen offset:1024
    buffer_load_dword v129, v15, s[8:11], s31 offen offset:1280
    buffer_load_dword v130, v15, s[8:11], s31 offen offset:1536
    buffer_load_dword v131, v15, s[8:11], s31 offen offset:1792
    s_mov_b32 s32, s28
    s_and_b32 s33, s29, 0xffff
    s_mov_b32 s34, 0x400000
    s_mov_b32 s35, 0x00020000
    s_add_u32 s36, s6, 0x1000000
    s_addc_u32 s37, s7, 0x0
    s_and_b32 s37, s37, 0xffff
    s_mov_b32 s38, 0x400000
    s_mov_b32 s39, 0x00020000
    s_mov_b32 s16, 0x3f3504f3
    s_mov_b32 s17, 0x3f3504f3
    s_mov_b32 s19, 0x3727c5ac
    v_cmp_eq_u32 vcc, 0, v6
    v_mov_b32 v60, 0
    s_waitcnt vmcnt(8)
    v_cndmask_b32 v105, v105, v60, vcc
    v_cndmask_b32 v107, v107, v60, vcc
    v_add_u32 v7, 0, v6
    v_cvt_f32_u32 v60, v7
    v_mul_f32 v60, 0xba800000, v60
    v_cos_f32 v62, v60
    v_sin_f32 v63, v60
    v_pk_add_f32 v[50:51], v[104:105], v[106:107] neg_hi:[0,1]
    v_pk_add_f32 v[52:53], v[104:105], v[106:107] neg_lo:[0,1]
    v_pk_mul_f32 v[56:57], v[52:53], v[62:63] op_sel:[0,0] op_sel_hi:[1,0]
    v_pk_fma_f32 v[54:55], v[52:53], v[62:63], v[56:57] op_sel:[1,1,0] op_sel_hi:[0,1,1] neg_lo:[1,0,0]
    v_pk_add_f32 v[56:57], v[50:51], v[54:55] op_sel:[0,1] op_sel_hi:[1,0] neg_hi:[0,1]
    v_pk_add_f32 v[58:59], v[50:51], v[54:55] op_sel:[0,1] op_sel_hi:[1,0] neg_lo:[0,1] neg_hi:[1,1]
    v_sub_u32 v8, 512, v7
    v_and_b32 v8, 511, v8
    v_lshl_add_u32 v7, v7, 3, v12
    v_lshl_add_u32 v8, v8, 3, v12
    ds_write_b64 v7, v[56:57]
    ds_write_b64 v8, v[58:59]
    v_add_u32 v7, 64, v6
    v_cvt_f32_u32 v60, v7
    v_mul_f32 v60, 0xba800000, v60
    v_cos_f32 v62, v60
    v_sin_f32 v63, v60
    v_pk_add_f32 v[50:51], v[108:109], v[110:111] neg_hi:[0,1]
    v_pk_add_f32 v[52:53], v[108:109], v[110:111] neg_lo:[0,1]
    v_pk_mul_f32 v[56:57], v[52:53], v[62:63] op_sel:[0,0] op_sel_hi:[1,0]
    v_pk_fma_f32 v[54:55], v[52:53], v[62:63], v[56:57] op_sel:[1,1,0] op_sel_hi:[0,1,1] neg_lo:[1,0,0]
    v_pk_add_f32 v[56:57], v[50:51], v[54:55] op_sel:[0,1] op_sel_hi:[1,0] neg_hi:[0,1]
    v_pk_add_f32 v[58:59], v[50:51], v[54:55] op_sel:[0,1] op_sel_hi:[1,0] neg_lo:[0,1] neg_hi:[1,1]
    v_sub_u32 v8, 512, v7
    v_and_b32 v8, 511, v8
    v_lshl_add_u32 v7, v7, 3, v12
    v_lshl_add_u32 v8, v8, 3, v12
    ds_write_b64 v7, v[56:57]
    ds_write_b64 v8, v[58:59]
    v_add_u32 v7, 128, v6
    v_cvt_f32_u32 v60, v7
    v_mul_f32 v60, 0xba800000, v60
    v_cos_f32 v62, v60
    v_sin_f32 v63, v60
    v_pk_add_f32 v[50:51], v[112:113], v[114:115] neg_hi:[0,1]
    v_pk_add_f32 v[52:53], v[112:113], v[114:115] neg_lo:[0,1]
    v_pk_mul_f32 v[56:57], v[52:53], v[62:63] op_sel:[0,0] op_sel_hi:[1,0]
    v_pk_fma_f32 v[54:55], v[52:53], v[62:63], v[56:57] op_sel:[1,1,0] op_sel_hi:[0,1,1] neg_lo:[1,0,0]
    v_pk_add_f32 v[56:57], v[50:51], v[54:55] op_sel:[0,1] op_sel_hi:[1,0] neg_hi:[0,1]
    v_pk_add_f32 v[58:59], v[50:51], v[54:55] op_sel:[0,1] op_sel_hi:[1,0] neg_lo:[0,1] neg_hi:[1,1]
    v_sub_u32 v8, 512, v7
    v_and_b32 v8, 511, v8
    v_lshl_add_u32 v7, v7, 3, v12
    v_lshl_add_u32 v8, v8, 3, v12
    ds_write_b64 v7, v[56:57]
    ds_write_b64 v8, v[58:59]
    v_add_u32 v7, 192, v6
    v_cvt_f32_u32 v60, v7
    v_mul_f32 v60, 0xba800000, v60
    v_cos_f32 v62, v60
    v_sin_f32 v63, v60
    v_pk_add_f32 v[50:51], v[116:117], v[118:119] neg_hi:[0,1]
    v_pk_add_f32 v[52:53], v[116:117], v[118:119] neg_lo:[0,1]
    v_pk_mul_f32 v[56:57], v[52:53], v[62:63] op_sel:[0,0] op_sel_hi:[1,0]
    v_pk_fma_f32 v[54:55], v[52:53], v[62:63], v[56:57] op_sel:[1,1,0] op_sel_hi:[0,1,1] neg_lo:[1,0,0]
    v_pk_add_f32 v[56:57], v[50:51], v[54:55] op_sel:[0,1] op_sel_hi:[1,0] neg_hi:[0,1]
    v_pk_add_f32 v[58:59], v[50:51], v[54:55] op_sel:[0,1] op_sel_hi:[1,0] neg_lo:[0,1] neg_hi:[1,1]
    v_sub_u32 v8, 512, v7
    v_and_b32 v8, 511, v8
    v_lshl_add_u32 v7, v7, 3, v12
    v_lshl_add_u32 v8, v8, 3, v12
    ds_write_b64 v7, v[56:57]
    ds_write_b64 v8, v[58:59]
    v_cmp_gt_u32 vcc, 8, v0
    s_and_saveexec_b64 s[24:25], vcc
    s_cbranch_execz K3_SKIP
    v_add_u32 v7, 256, v6
    v_cvt_f32_u32 v60, v7
    v_mul_f32 v60, 0xba800000, v60
    v_cos_f32 v62, v60
    v_sin_f32 v63, v60
    v_pk_add_f32 v[50:51], v[120:121], v[122:123] neg_hi:[0,1]
    v_pk_add_f32 v[52:53], v[120:121], v[122:123] neg_lo:[0,1]
    v_pk_mul_f32 v[56:57], v[52:53], v[62:63] op_sel:[0,0] op_sel_hi:[1,0]
    v_pk_fma_f32 v[54:55], v[52:53], v[62:63], v[56:57] op_sel:[1,1,0] op_sel_hi:[0,1,1] neg_lo:[1,0,0]
    v_pk_add_f32 v[56:57], v[50:51], v[54:55] op_sel:[0,1] op_sel_hi:[1,0] neg_hi:[0,1]
    v_pk_add_f32 v[58:59], v[50:51], v[54:55] op_sel:[0,1] op_sel_hi:[1,0] neg_lo:[0,1] neg_hi:[1,1]
    v_sub_u32 v8, 512, v7
    v_and_b32 v8, 511, v8
    v_lshl_add_u32 v7, v7, 3, v12
    v_lshl_add_u32 v8, v8, 3, v12
    ds_write_b64 v7, v[56:57]
    ds_write_b64 v8, v[58:59]
K3_SKIP:
    s_mov_b64 exec, -1
    v_mul_u32_u24 v4, 4128, v2
    v_lshl_add_u32 v3, v1, 3, v4
    s_waitcnt lgkmcnt(0)
    s_barrier
    ds_read_b64 v[20:21], v3 offset:0
    ds_read_b64 v[22:23], v3 offset:512
    ds_read_b64 v[24:25], v3 offset:1024
    ds_read_b64 v[26:27], v3 offset:1536
    ds_read_b64 v[28:29], v3 offset:2048
    ds_read_b64 v[30:31], v3 offset:2560
    ds_read_b64 v[32:33], v3 offset:3072
    ds_read_b64 v[34:35], v3 offset:3584
    s_waitcnt lgkmcnt(0)
    s_mov_b32 s20, 0
    s_mov_b32 s22, 0xbe000000
K3_PASS:
    v_lshlrev_b32 v5, s20, 1
    v_add_u32 v5, -1, v5
    v_and_b32 v6, v1, v5
    v_lshrrev_b32 v7, s20, v1
    s_add_u32 s21, s20, 3
    v_lshlrev_b32 v7, s21, v7
    v_add_u32 v7, v7, v6
    v_lshl_add_u32 v7, v7, 3, v4
    v_cvt_f32_u32 v6, v6
    v_mul_f32 v6, s22, v6
    v_cos_f32 v80, v6
    v_sin_f32 v81, v6
    v_mul_f32 v99, 2.0, v6
    v_cos_f32 v82, v99
    v_sin_f32 v83, v99
    v_mul_f32 v98, 0x40400000, v6
    v_cos_f32 v84, v98
    v_sin_f32 v85, v98
    v_mul_f32 v99, 4.0, v6
    v_cos_f32 v86, v99
    v_sin_f32 v87, v99
    v_mul_f32 v98, 0x40a00000, v6
    v_cos_f32 v88, v98
    v_sin_f32 v89, v98
    v_mul_f32 v99, 0x40c00000, v6
    v_cos_f32 v90, v99
    v_sin_f32 v91, v99
    v_mul_f32 v98, 0x40e00000, v6
    v_cos_f32 v92, v98
    v_sin_f32 v93, v98
    s_lshl_b32 s23, 8, s20
    v_pk_mul_f32 v[94:95], v[22:23], v[80:81] op_sel:[0,0] op_sel_hi:[1,0]
    v_pk_fma_f32 v[22:23], v[22:23], v[80:81], v[94:95] op_sel:[1,1,0] op_sel_hi:[0,1,1] neg_lo:[1,0,0]
    v_pk_mul_f32 v[94:95], v[24:25], v[82:83] op_sel:[0,0] op_sel_hi:[1,0]
    v_pk_fma_f32 v[24:25], v[24:25], v[82:83], v[94:95] op_sel:[1,1,0] op_sel_hi:[0,1,1] neg_lo:[1,0,0]
    v_pk_mul_f32 v[94:95], v[26:27], v[84:85] op_sel:[0,0] op_sel_hi:[1,0]
    v_pk_fma_f32 v[26:27], v[26:27], v[84:85], v[94:95] op_sel:[1,1,0] op_sel_hi:[0,1,1] neg_lo:[1,0,0]
    v_pk_mul_f32 v[94:95], v[28:29], v[86:87] op_sel:[0,0] op_sel_hi:[1,0]
    v_pk_fma_f32 v[28:29], v[28:29], v[86:87], v[94:95] op_sel:[1,1,0] op_sel_hi:[0,1,1] neg_lo:[1,0,0]
    v_pk_mul_f32 v[94:95], v[30:31], v[88:89] op_sel:[0,0] op_sel_hi:[1,0]
    v_pk_fma_f32 v[30:31], v[30:31], v[88:89], v[94:95] op_sel:[1,1,0] op_sel_hi:[0,1,1] neg_lo:[1,0,0]
    v_pk_mul_f32 v[94:95], v[32:33], v[90:91] op_sel:[0,0] op_sel_hi:[1,0]
    v_pk_fma_f32 v[32:33], v[32:33], v[90:91], v[94:95] op_sel:[1,1,0] op_sel_hi:[0,1,1] neg_lo:[1,0,0]
    v_pk_mul_f32 v[94:95], v[34:35], v[92:93] op_sel:[0,0] op_sel_hi:[1,0]
    v_pk_fma_f32 v[34:35], v[34:35], v[92:93], v[94:95] op_sel:[1,1,0] op_sel_hi:[0,1,1] neg_lo:[1,0,0]
    v_pk_add_f32 v[52:53], v[20:21], v[28:29]
    v_pk_add_f32 v[60:61], v[20:21], v[28:29] neg_lo:[0,1] neg_hi:[0,1]
    v_pk_add_f32 v[54:55], v[22:23], v[30:31]
    v_pk_add_f32 v[62:63], v[22:23], v[30:31] neg_lo:[0,1] neg_hi:[0,1]
    v_pk_add_f32 v[56:57], v[24:25], v[32:33]
    v_pk_add_f32 v[64:65], v[24:25], v[32:33] neg_lo:[0,1] neg_hi:[0,1]
    v_pk_add_f32 v[58:59], v[26:27], v[34:35]
    v_pk_add_f32 v[66:67], v[26:27], v[34:35] neg_lo:[0,1] neg_hi:[0,1]
    v_pk_add_f32 v[72:73], v[52:53], v[56:57]
    v_pk_add_f32 v[76:77], v[52:53], v[56:57] neg_lo:[0,1] neg_hi:[0,1]
    v_pk_add_f32 v[74:75], v[54:55], v[58:59]
    v_pk_add_f32 v[78:79], v[54:55], v[58:59] neg_lo:[0,1] neg_hi:[0,1]
    v_pk_add_f32 v[36:37], v[72:73], v[74:75]
    v_pk_add_f32 v[44:45], v[72:73], v[74:75] neg_lo:[0,1] neg_hi:[0,1]
    v_pk_add_f32 v[40:41], v[76:77], v[78:79] op_sel:[0,1] op_sel_hi:[1,0] neg_hi:[0,1]
    v_pk_add_f32 v[48:49], v[76:77], v[78:79] op_sel:[0,1] op_sel_hi:[1,0] neg_lo:[0,1]
    v_pk_add_f32 v[68:69], v[62:63], v[62:63] op_sel:[0,1] op_sel_hi:[1,0] neg_hi:[0,1]
    v_pk_mul_f32 v[68:69], v[68:69], s[16:17]
    v_pk_add_f32 v[70:71], v[66:67], v[66:67] op_sel:[0,1] op_sel_hi:[1,0] neg_hi:[0,1]
    v_pk_mul_f32 v[70:71], v[70:71], s[16:17]
    v_pk_add_f32 v[72:73], v[60:61], v[64:65] op_sel:[0,1] op_sel_hi:[1,0] neg_hi:[0,1]
    v_pk_add_f32 v[76:77], v[60:61], v[64:65] op_sel:[0,1] op_sel_hi:[1,0] neg_lo:[0,1]
    v_pk_add_f32 v[74:75], v[68:69], v[70:71] op_sel:[0,1] op_sel_hi:[1,0] neg_hi:[0,1]
    v_pk_add_f32 v[78:79], v[68:69], v[70:71] op_sel:[0,1] op_sel_hi:[1,0] neg_lo:[0,1]
    v_pk_add_f32 v[38:39], v[72:73], v[74:75]
    v_pk_add_f32 v[46:47], v[72:73], v[74:75] neg_lo:[0,1] neg_hi:[0,1]
    v_pk_add_f32 v[42:43], v[76:77], v[78:79] op_sel:[0,1] op_sel_hi:[1,0] neg_hi:[0,1]
    v_pk_add_f32 v[50:51], v[76:77], v[78:79] op_sel:[0,1] op_sel_hi:[1,0] neg_lo:[0,1]
    ds_write_b64 v7, v[36:37]
    v_add_u32 v7, s23, v7
    ds_write_b64 v7, v[38:39]
    v_add_u32 v7, s23, v7
    ds_write_b64 v7, v[40:41]
    v_add_u32 v7, s23, v7
    ds_write_b64 v7, v[42:43]
    v_add_u32 v7, s23, v7
    ds_write_b64 v7, v[44:45]
    v_add_u32 v7, s23, v7
    ds_write_b64 v7, v[46:47]
    v_add_u32 v7, s23, v7
    ds_write_b64 v7, v[48:49]
    v_add_u32 v7, s23, v7
    ds_write_b64 v7, v[50:51]
    s_cmp_eq_u32 s20, 6
    s_cbranch_scc1 K3_PASSDONE
    ds_read_b64 v[20:21], v3 offset:0
    ds_read_b64 v[22:23], v3 offset:512
    ds_read_b64 v[24:25], v3 offset:1024
    ds_read_b64 v[26:27], v3 offset:1536
    ds_read_b64 v[28:29], v3 offset:2048
    ds_read_b64 v[30:31], v3 offset:2560
    ds_read_b64 v[32:33], v3 offset:3072
    ds_read_b64 v[34:35], v3 offset:3584
    s_add_u32 s20, s20, 3
    s_sub_u32 s22, s22, 0x01800000
    s_waitcnt lgkmcnt(0)
    s_branch K3_PASS
K3_PASSDONE:
    s_waitcnt vmcnt(0)
    v_cvt_pk_bf16_f32 v36, v36, -v37
    v_and_b32 v37, 0xffff0000, v36
    v_lshlrev_b32 v36, 16, v36
    v_lshlrev_b32 v94, 16, v124
    v_and_b32 v95, 0xffff0000, v124
    v_pk_add_f32 v[36:37], v[36:37], v[94:95]
    v_cvt_pk_bf16_f32 v104, v36, v37
    buffer_store_dword v104, v15, s[32:35], s31 offen offset:0
    v_lshlrev_b32 v36, 16, v104
    v_and_b32 v37, 0xffff0000, v104
    v_cvt_pk_bf16_f32 v38, v38, -v39
    v_and_b32 v39, 0xffff0000, v38
    v_lshlrev_b32 v38, 16, v38
    v_lshlrev_b32 v94, 16, v125
    v_and_b32 v95, 0xffff0000, v125
    v_pk_add_f32 v[38:39], v[38:39], v[94:95]
    v_cvt_pk_bf16_f32 v105, v38, v39
    buffer_store_dword v105, v15, s[32:35], s31 offen offset:256
    v_lshlrev_b32 v38, 16, v105
    v_and_b32 v39, 0xffff0000, v105
    v_cvt_pk_bf16_f32 v40, v40, -v41
    v_and_b32 v41, 0xffff0000, v40
    v_lshlrev_b32 v40, 16, v40
    v_lshlrev_b32 v94, 16, v126
    v_and_b32 v95, 0xffff0000, v126
    v_pk_add_f32 v[40:41], v[40:41], v[94:95]
    v_cvt_pk_bf16_f32 v106, v40, v41
    buffer_store_dword v106, v15, s[32:35], s31 offen offset:512
    v_lshlrev_b32 v40, 16, v106
    v_and_b32 v41, 0xffff0000, v106
    v_cvt_pk_bf16_f32 v42, v42, -v43
    v_and_b32 v43, 0xffff0000, v42
    v_lshlrev_b32 v42, 16, v42
    v_lshlrev_b32 v94, 16, v127
    v_and_b32 v95, 0xffff0000, v127
    v_pk_add_f32 v[42:43], v[42:43], v[94:95]
    v_cvt_pk_bf16_f32 v107, v42, v43
    buffer_store_dword v107, v15, s[32:35], s31 offen offset:768
    v_lshlrev_b32 v42, 16, v107
    v_and_b32 v43, 0xffff0000, v107
    v_cvt_pk_bf16_f32 v44, v44, -v45
    v_and_b32 v45, 0xffff0000, v44
    v_lshlrev_b32 v44, 16, v44
    v_lshlrev_b32 v94, 16, v128
    v_and_b32 v95, 0xffff0000, v128
    v_pk_add_f32 v[44:45], v[44:45], v[94:95]
    v_cvt_pk_bf16_f32 v108, v44, v45
    buffer_store_dword v108, v15, s[32:35], s31 offen offset:1024
    v_lshlrev_b32 v44, 16, v108
    v_and_b32 v45, 0xffff0000, v108
    v_cvt_pk_bf16_f32 v46, v46, -v47
    v_and_b32 v47, 0xffff0000, v46
    v_lshlrev_b32 v46, 16, v46
    v_lshlrev_b32 v94, 16, v129
    v_and_b32 v95, 0xffff0000, v129
    v_pk_add_f32 v[46:47], v[46:47], v[94:95]
    v_cvt_pk_bf16_f32 v109, v46, v47
    buffer_store_dword v109, v15, s[32:35], s31 offen offset:1280
    v_lshlrev_b32 v46, 16, v109
    v_and_b32 v47, 0xffff0000, v109
    v_cvt_pk_bf16_f32 v48, v48, -v49
    v_and_b32 v49, 0xffff0000, v48
    v_lshlrev_b32 v48, 16, v48
    v_lshlrev_b32 v94, 16, v130
    v_and_b32 v95, 0xffff0000, v130
    v_pk_add_f32 v[48:49], v[48:49], v[94:95]
    v_cvt_pk_bf16_f32 v110, v48, v49
    buffer_store_dword v110, v15, s[32:35], s31 offen offset:1536
    v_lshlrev_b32 v48, 16, v110
    v_and_b32 v49, 0xffff0000, v110
    v_cvt_pk_bf16_f32 v50, v50, -v51
    v_and_b32 v51, 0xffff0000, v50
    v_lshlrev_b32 v50, 16, v50
    v_lshlrev_b32 v94, 16, v131
    v_and_b32 v95, 0xffff0000, v131
    v_pk_add_f32 v[50:51], v[50:51], v[94:95]
    v_cvt_pk_bf16_f32 v111, v50, v51
    buffer_store_dword v111, v15, s[32:35], s31 offen offset:1792
    v_lshlrev_b32 v50, 16, v111
    v_and_b32 v51, 0xffff0000, v111
    v_pk_add_f32 v[94:95], v[36:37], v[38:39]
    v_pk_add_f32 v[94:95], v[94:95], v[40:41]
    v_pk_add_f32 v[94:95], v[94:95], v[42:43]
    v_pk_add_f32 v[94:95], v[94:95], v[44:45]
    v_pk_add_f32 v[94:95], v[94:95], v[46:47]
    v_pk_add_f32 v[94:95], v[94:95], v[48:49]
    v_pk_add_f32 v[94:95], v[94:95], v[50:51]
    v_add_f32 v94, v94, v95
    s_nop 1
    v_add_f32_dpp v98, v94, v94 quad_perm:[1,0,3,2] row_mask:0xf bank_mask:0xf
    s_nop 1
    v_add_f32_dpp v94, v98, v98 quad_perm:[2,3,0,1] row_mask:0xf bank_mask:0xf
    s_nop 1
    v_add_f32_dpp v98, v94, v94 row_half_mirror row_mask:0xf bank_mask:0xf
    s_nop 1
    v_add_f32_dpp v94, v98, v98 row_mirror row_mask:0xf bank_mask:0xf
    s_nop 1
    v_readlane_b32 s24, v94, 0
    v_readlane_b32 s25, v94, 16
    v_readlane_b32 s26, v94, 32
    v_readlane_b32 s27, v94, 48
    s_nop 1
    v_mov_b32 v94, s24
    v_add_f32 v94, s25, v94
    v_add_f32 v94, s26, v94
    v_add_f32 v94, s27, v94
    v_mul_f32 v94, 0x3a800000, v94
    v_mov_b32 v95, v94
    v_pk_add_f32 v[98:99], v[36:37], v[94:95] neg_lo:[0,1] neg_hi:[0,1]
    v_pk_mul_f32 v[96:97], v[98:99], v[98:99]
    v_pk_add_f32 v[98:99], v[38:39], v[94:95] neg_lo:[0,1] neg_hi:[0,1]
    v_pk_fma_f32 v[96:97], v[98:99], v[98:99], v[96:97]
    v_pk_add_f32 v[98:99], v[40:41], v[94:95] neg_lo:[0,1] neg_hi:[0,1]
    v_pk_fma_f32 v[96:97], v[98:99], v[98:99], v[96:97]
    v_pk_add_f32 v[98:99], v[42:43], v[94:95] neg_lo:[0,1] neg_hi:[0,1]
    v_pk_fma_f32 v[96:97], v[98:99], v[98:99], v[96:97]
    v_pk_add_f32 v[98:99], v[44:45], v[94:95] neg_lo:[0,1] neg_hi:[0,1]
    v_pk_fma_f32 v[96:97], v[98:99], v[98:99], v[96:97]
    v_pk_add_f32 v[98:99], v[46:47], v[94:95] neg_lo:[0,1] neg_hi:[0,1]
    v_pk_fma_f32 v[96:97], v[98:99], v[98:99], v[96:97]
    v_pk_add_f32 v[98:99], v[48:49], v[94:95] neg_lo:[0,1] neg_hi:[0,1]
    v_pk_fma_f32 v[96:97], v[98:99], v[98:99], v[96:97]
    v_pk_add_f32 v[98:99], v[50:51], v[94:95] neg_lo:[0,1] neg_hi:[0,1]
    v_pk_fma_f32 v[96:97], v[98:99], v[98:99], v[96:97]
    v_add_f32 v96, v96, v97
    s_nop 1
    v_add_f32_dpp v98, v96, v96 quad_perm:[1,0,3,2] row_mask:0xf bank_mask:0xf
    s_nop 1
    v_add_f32_dpp v96, v98, v98 quad_perm:[2,3,0,1] row_mask:0xf bank_mask:0xf
    s_nop 1
    v_add_f32_dpp v98, v96, v96 row_half_mirror row_mask:0xf bank_mask:0xf
    s_nop 1
    v_add_f32_dpp v96, v98, v98 row_mirror row_mask:0xf bank_mask:0xf
    s_nop 1
    v_readlane_b32 s24, v96, 0
    v_readlane_b32 s25, v96, 16
    v_readlane_b32 s26, v96, 32
    v_readlane_b32 s27, v96, 48
    s_nop 1
    v_mov_b32 v96, s24
    v_add_f32 v96, s25, v96
    v_add_f32 v96, s26, v96
    v_add_f32 v96, s27, v96
    v_mul_f32 v96, 0x3a800000, v96
    v_cvt_pk_bf16_f32 v94, v94, v94
    v_lshlrev_b32 v94, 16, v94
    v_mov_b32 v95, v94
    v_cvt_pk_bf16_f32 v96, v96, v96
    v_lshlrev_b32 v96, 16, v96
    v_add_f32 v96, s19, v96
    v_cvt_pk_bf16_f32 v96, v96, v96
    v_lshlrev_b32 v96, 16, v96
    v_sqrt_f32 v96, v96
    s_nop 0
    v_cvt_pk_bf16_f32 v96, v96, v96
    v_lshlrev_b32 v96, 16, v96
    v_rcp_f32 v99, v96
    v_mov_b32 v97, v96
    v_mov_b32 v98, v99
    v_pk_add_f32 v[36:37], v[36:37], v[94:95] neg_lo:[0,1] neg_hi:[0,1]
    v_cvt_pk_bf16_f32 v36, v36, v37
    v_and_b32 v37, 0xffff0000, v36
    v_lshlrev_b32 v36, 16, v36
    v_pk_mul_f32 v[100:101], v[36:37], v[98:99]
    v_pk_fma_f32 v[102:103], v[100:101], v[96:97], v[36:37] neg_lo:[1,0,0] neg_hi:[1,0,0]
    v_pk_fma_f32 v[36:37], v[102:103], v[98:99], v[100:101]
    v_pk_add_f32 v[38:39], v[38:39], v[94:95] neg_lo:[0,1] neg_hi:[0,1]
    v_cvt_pk_bf16_f32 v38, v38, v39
    v_and_b32 v39, 0xffff0000, v38
    v_lshlrev_b32 v38, 16, v38
    v_pk_mul_f32 v[100:101], v[38:39], v[98:99]
    v_pk_fma_f32 v[102:103], v[100:101], v[96:97], v[38:39] neg_lo:[1,0,0] neg_hi:[1,0,0]
    v_pk_fma_f32 v[38:39], v[102:103], v[98:99], v[100:101]
    v_pk_add_f32 v[40:41], v[40:41], v[94:95] neg_lo:[0,1] neg_hi:[0,1]
    v_cvt_pk_bf16_f32 v40, v40, v41
    v_and_b32 v41, 0xffff0000, v40
    v_lshlrev_b32 v40, 16, v40
    v_pk_mul_f32 v[100:101], v[40:41], v[98:99]
    v_pk_fma_f32 v[102:103], v[100:101], v[96:97], v[40:41] neg_lo:[1,0,0] neg_hi:[1,0,0]
    v_pk_fma_f32 v[40:41], v[102:103], v[98:99], v[100:101]
    v_pk_add_f32 v[42:43], v[42:43], v[94:95] neg_lo:[0,1] neg_hi:[0,1]
    v_cvt_pk_bf16_f32 v42, v42, v43
    v_and_b32 v43, 0xffff0000, v42
    v_lshlrev_b32 v42, 16, v42
    v_pk_mul_f32 v[100:101], v[42:43], v[98:99]
    v_pk_fma_f32 v[102:103], v[100:101], v[96:97], v[42:43] neg_lo:[1,0,0] neg_hi:[1,0,0]
    v_pk_fma_f32 v[42:43], v[102:103], v[98:99], v[100:101]
    v_pk_add_f32 v[44:45], v[44:45], v[94:95] neg_lo:[0,1] neg_hi:[0,1]
    v_cvt_pk_bf16_f32 v44, v44, v45
    v_and_b32 v45, 0xffff0000, v44
    v_lshlrev_b32 v44, 16, v44
    v_pk_mul_f32 v[100:101], v[44:45], v[98:99]
    v_pk_fma_f32 v[102:103], v[100:101], v[96:97], v[44:45] neg_lo:[1,0,0] neg_hi:[1,0,0]
    v_pk_fma_f32 v[44:45], v[102:103], v[98:99], v[100:101]
    v_pk_add_f32 v[46:47], v[46:47], v[94:95] neg_lo:[0,1] neg_hi:[0,1]
    v_cvt_pk_bf16_f32 v46, v46, v47
    v_and_b32 v47, 0xffff0000, v46
    v_lshlrev_b32 v46, 16, v46
    v_pk_mul_f32 v[100:101], v[46:47], v[98:99]
    v_pk_fma_f32 v[102:103], v[100:101], v[96:97], v[46:47] neg_lo:[1,0,0] neg_hi:[1,0,0]
    v_pk_fma_f32 v[46:47], v[102:103], v[98:99], v[100:101]
    v_pk_add_f32 v[48:49], v[48:49], v[94:95] neg_lo:[0,1] neg_hi:[0,1]
    v_cvt_pk_bf16_f32 v48, v48, v49
    v_and_b32 v49, 0xffff0000, v48
    v_lshlrev_b32 v48, 16, v48
    v_pk_mul_f32 v[100:101], v[48:49], v[98:99]
    v_pk_fma_f32 v[102:103], v[100:101], v[96:97], v[48:49] neg_lo:[1,0,0] neg_hi:[1,0,0]
    v_pk_fma_f32 v[48:49], v[102:103], v[98:99], v[100:101]
    v_pk_add_f32 v[50:51], v[50:51], v[94:95] neg_lo:[0,1] neg_hi:[0,1]
    v_cvt_pk_bf16_f32 v50, v50, v51
    v_and_b32 v51, 0xffff0000, v50
    v_lshlrev_b32 v50, 16, v50
    v_pk_mul_f32 v[100:101], v[50:51], v[98:99]
    v_pk_fma_f32 v[102:103], v[100:101], v[96:97], v[50:51] neg_lo:[1,0,0] neg_hi:[1,0,0]
    v_pk_fma_f32 v[50:51], v[102:103], v[98:99], v[100:101]
    v_cvt_pk_bf16_f32 v20, v36, v37
    buffer_store_dword v20, v15, s[36:39], s31 offen offset:0
    v_cvt_pk_bf16_f32 v21, v38, v39
    buffer_store_dword v21, v15, s[36:39], s31 offen offset:256
    v_cvt_pk_bf16_f32 v22, v40, v41
    buffer_store_dword v22, v15, s[36:39], s31 offen offset:512
    v_cvt_pk_bf16_f32 v23, v42, v43
    buffer_store_dword v23, v15, s[36:39], s31 offen offset:768
    v_cvt_pk_bf16_f32 v24, v44, v45
    buffer_store_dword v24, v15, s[36:39], s31 offen offset:1024
    v_cvt_pk_bf16_f32 v25, v46, v47
    buffer_store_dword v25, v15, s[36:39], s31 offen offset:1280
    v_cvt_pk_bf16_f32 v26, v48, v49
    buffer_store_dword v26, v15, s[36:39], s31 offen offset:1536
    v_cvt_pk_bf16_f32 v27, v50, v51
    buffer_store_dword v27, v15, s[36:39], s31 offen offset:1792
K3_END:
    s_endpgm
K3_PF:
    s_cmp_ge_u32 s2, 256
    s_cbranch_scc1 K3_PFEND
    s_and_b32 s17, s2, 7
    s_sub_u32 s2, s2, 256
    s_lshr_b32 s3, s2, 3
    v_lshrrev_b32 v5, 8, v0
    s_nop 0
    v_readfirstlane_b32 s26, v5
    v_and_b32 v0, 255, v0
    s_lshl_b32 s3, s3, 1
    s_add_u32 s3, s3, s26
    s_add_u32 s3, s3, 64
    s_load_dwordx4 s[4:7], s[0:1], 32
    s_load_dwordx2 s[24:25], s[0:1], 48
    s_lshr_b32 s18, s17, 1
    s_mul_i32 s18, s18, 1792
    s_mul_i32 s19, s3, 16*7168
    s_add_u32 s18, s18, s19
    v_cmp_gt_u32 vcc, 112, v0
    v_mov_b32 v2, 7168-1792
    s_nop 0
    v_cndmask_b32 v2, v2, 0, vcc
    v_lshl_add_u32 v1, v0, 4, v2
    s_mul_i32 s19, s3, 56
    s_and_b32 s20, s17, 3
    s_mul_i32 s20, s20, 14
    s_add_u32 s19, s19, s20
    s_lshl_b32 s19, s19, 11
    s_lshr_b32 s20, s17, 2
    s_lshl_b32 s20, s20, 10
    s_add_u32 s19, s19, s20
    v_lshrrev_b32 v3, 6, v0
    v_and_b32 v4, 63, v0
    v_lshlrev_b32 v4, 4, v4
    v_lshl_add_u32 v3, v3, 11, v4
    s_waitcnt lgkmcnt(0)
    s_mov_b32 s8, s4
    s_and_b32 s9, s5, 0xffff
    s_mov_b32 s10, 0x700000
    s_mov_b32 s11, 0x00020000
    s_mov_b32 s12, s6
    s_and_b32 s13, s7, 0xffff
    s_mov_b32 s14, 0x700000
    s_mov_b32 s15, 0x00020000
    s_mov_b32 s28, s24
    s_and_b32 s29, s25, 0xffff
    s_mov_b32 s30, 0x700000
    s_mov_b32 s31, 0x00020000
    s_add_u32 s23, s19, 0
    buffer_load_dwordx4 v[80:83], v3, s[28:31], s23 offen
    s_add_u32 s23, s19, 8192
    buffer_load_dwordx4 v[84:87], v3, s[28:31], s23 offen
    s_add_u32 s23, s19, 16384
    buffer_load_dwordx4 v[88:91], v3, s[28:31], s23 offen
    s_add_u32 s23, s19, 24576
    buffer_load_dwordx4 v[92:95], v3, s[28:31], s23 offen
    v_cmp_gt_u32 vcc, 224, v0
    s_and_saveexec_b64 s[20:21], vcc
    s_cbranch_execz K3_PFEND
    s_add_u32 s23, s18, 0
    buffer_load_dwordx4 v[8:11], v1, s[8:11], s23 offen
    buffer_load_dwordx4 v[12:15], v1, s[12:15], s23 offen
    s_add_u32 s23, s18, 14336
    buffer_load_dwordx4 v[16:19], v1, s[8:11], s23 offen
    buffer_load_dwordx4 v[20:23], v1, s[12:15], s23 offen
    s_add_u32 s23, s18, 28672
    buffer_load_dwordx4 v[24:27], v1, s[8:11], s23 offen
    buffer_load_dwordx4 v[28:31], v1, s[12:15], s23 offen
    s_add_u32 s23, s18, 43008
    buffer_load_dwordx4 v[32:35], v1, s[8:11], s23 offen
    buffer_load_dwordx4 v[36:39], v1, s[12:15], s23 offen
    s_add_u32 s23, s18, 57344
    buffer_load_dwordx4 v[40:43], v1, s[8:11], s23 offen
    buffer_load_dwordx4 v[44:47], v1, s[12:15], s23 offen
    s_add_u32 s23, s18, 71680
    buffer_load_dwordx4 v[48:51], v1, s[8:11], s23 offen
    buffer_load_dwordx4 v[52:55], v1, s[12:15], s23 offen
    s_add_u32 s23, s18, 86016
    buffer_load_dwordx4 v[56:59], v1, s[8:11], s23 offen
    buffer_load_dwordx4 v[60:63], v1, s[12:15], s23 offen
    s_add_u32 s23, s18, 100352
    buffer_load_dwordx4 v[64:67], v1, s[8:11], s23 offen
    buffer_load_dwordx4 v[68:71], v1, s[12:15], s23 offen
K3_PFEND:
    s_endpgm
.globl k4_kernel
.p2align 8
.type k4_kernel,@function
k4_kernel:
    s_cmp_ge_u32 s2, 256
    s_cbranch_scc1 K4_END
    s_load_dwordx4 s[4:7], s[0:1], 32
    s_load_dwordx2 s[28:29], s[0:1], 72
    v_and_b32 v1, 63, v0
    v_lshrrev_b32 v2, 6, v0
    s_nop 0
    v_readfirstlane_b32 s27, v2
    s_and_b32 s3, s2, 7
    s_lshr_b32 s34, s2, 3
    s_and_b32 s52, s34, 7
    s_lshr_b32 s34, s34, 3
    s_lshl_b32 s53, s3, 2
    s_add_u32 s53, s53, s34
    s_lshr_b32 s36, s27, 1
    s_and_b32 s37, s27, 1
    s_lshl_b32 s24, s52, 19
    s_lshl_b32 s3, s27, 16
    s_add_u32 s24, s24, s3
    s_and_b32 s3, s27, 3
    s_mul_i32 s25, s3, 16*7168
    s_mul_i32 s3, s53, 224
    s_add_u32 s25, s25, s3
    s_lshl_b32 s30, s27, 12
    s_add_u32 s31, s30, 32768
    v_lshrrev_b32 v3, 3, v1
    v_and_b32 v4, 7, v1
    v_xor_b32 v4, v4, v3
    v_lshlrev_b32 v4, 4, v4
    v_lshl_add_u32 v10, v3, 11, v4
    v_lshrrev_b32 v3, 4, v1
    v_and_b32 v4, 15, v1
    v_or_b32 v5, 0, v3
    v_lshlrev_b32 v5, 1, v5
    v_xor_b32 v5, v5, v4
    v_cmp_gt_u32 s[40:41], 14, v5
    v_lshlrev_b32 v5, 4, v5
    v_mul_u32_u24 v6, 7168, v3
    v_add_u32 v11, v6, v5
    v_or_b32 v5, 4, v3
    v_lshlrev_b32 v5, 1, v5
    v_xor_b32 v5, v5, v4
    v_cmp_gt_u32 s[42:43], 14, v5
    v_lshlrev_b32 v5, 4, v5
    v_mul_u32_u24 v6, 7168, v3
    v_add_u32 v12, v6, v5
    s_waitcnt lgkmcnt(0)
    s_add_u32 s8, s28, 0x1000000
    s_addc_u32 s9, s29, 0x0
    s_and_b32 s9, s9, 0xffff
    s_mov_b32 s10, 0x400000
    s_mov_b32 s11, 0x00020000
    s_cmp_ge_u32 s27, 4
    s_cselect_b32 s4, s6, s4
    s_cselect_b32 s5, s7, s5
    s_mov_b32 s12, s4
    s_and_b32 s13, s5, 0xffff
    s_mov_b32 s14, 0x700000
    s_mov_b32 s15, 0x00020000
    s_add_u32 s20, s28, 0x2000000
    s_addc_u32 s21, s29, 0x0
    s_and_b32 s21, s21, 0xffff
    s_mov_b32 s22, 0xe00000
    s_mov_b32 s23, 0x00020000
    s_add_u32 m0, s30, 0
    s_add_u32 s33, s24, 0
    buffer_load_dwordx4 v10, s[8:11], s33 offen lds
    s_add_u32 m0, s30, 1024
    s_add_u32 s33, s24, 16384
    buffer_load_dwordx4 v10, s[8:11], s33 offen lds
    s_add_u32 m0, s30, 2048
    s_add_u32 s33, s24, 32768
    buffer_load_dwordx4 v10, s[8:11], s33 offen lds
    s_add_u32 m0, s30, 3072
    s_add_u32 s33, s24, 49152
    buffer_load_dwordx4 v10, s[8:11], s33 offen lds
    s_add_u32 m0, s31, 0
    s_add_u32 s33, s25, 0
    s_mov_b64 exec, s[40:41]
    buffer_load_dwordx4 v11, s[12:15], s33 offen lds
    s_mov_b64 exec, -1
    s_add_u32 m0, s31, 1024
    s_add_u32 s33, s25, 28672
    s_mov_b64 exec, s[40:41]
    buffer_load_dwordx4 v11, s[12:15], s33 offen lds
    s_mov_b64 exec, -1
    s_add_u32 m0, s31, 2048
    s_add_u32 s33, s25, 57344
    s_mov_b64 exec, s[42:43]
    buffer_load_dwordx4 v12, s[12:15], s33 offen lds
    s_mov_b64 exec, -1
    s_add_u32 m0, s31, 3072
    s_add_u32 s33, s25, 86016
    s_mov_b64 exec, s[42:43]
    buffer_load_dwordx4 v12, s[12:15], s33 offen lds
    s_mov_b64 exec, -1
    s_add_u32 s24, s24, 128
    s_add_u32 s25, s25, 458752
    s_add_u32 m0, s30, 65536
    s_add_u32 s33, s24, 0
    buffer_load_dwordx4 v10, s[8:11], s33 offen lds
    s_add_u32 m0, s30, 66560
    s_add_u32 s33, s24, 16384
    buffer_load_dwordx4 v10, s[8:11], s33 offen lds
    s_add_u32 m0, s30, 67584
    s_add_u32 s33, s24, 32768
    buffer_load_dwordx4 v10, s[8:11], s33 offen lds
    s_add_u32 m0, s30, 68608
    s_add_u32 s33, s24, 49152
    buffer_load_dwordx4 v10, s[8:11], s33 offen lds
    s_add_u32 m0, s31, 65536
    s_add_u32 s33, s25, 0
    s_mov_b64 exec, s[40:41]
    buffer_load_dwordx4 v11, s[12:15], s33 offen lds
    s_mov_b64 exec, -1
    s_add_u32 m0, s31, 66560
    s_add_u32 s33, s25, 28672
    s_mov_b64 exec, s[40:41]
    buffer_load_dwordx4 v11, s[12:15], s33 offen lds
    s_mov_b64 exec, -1
    s_add_u32 m0, s31, 67584
    s_add_u32 s33, s25, 57344
    s_mov_b64 exec, s[42:43]
    buffer_load_dwordx4 v12, s[12:15], s33 offen lds
    s_mov_b64 exec, -1
    s_add_u32 m0, s31, 68608
    s_add_u32 s33, s25, 86016
    s_mov_b64 exec, s[42:43]
    buffer_load_dwordx4 v12, s[12:15], s33 offen lds
    s_mov_b64 exec, -1
    s_add_u32 s24, s24, 128
    s_add_u32 s25, s25, 458752
    v_and_b32 v3, 15, v1
    v_lshrrev_b32 v4, 4, v1
    v_and_b32 v5, 7, v1
    s_lshl_b32 s3, s36, 13
    v_add_u32 v6, 0, v4
    v_xor_b32 v6, v6, v5
    v_lshlrev_b32 v6, 4, v6
    v_lshl_add_u32 v6, v3, 7, v6
    v_add_u32 v14, s3, v6
    v_add_u32 v16, 65536, v14
    v_add_u32 v6, 4, v4
    v_xor_b32 v6, v6, v5
    v_lshlrev_b32 v6, 4, v6
    v_lshl_add_u32 v6, v3, 7, v6
    v_add_u32 v15, s3, v6
    v_add_u32 v17, 65536, v15
    v_lshrrev_b32 v5, 2, v3
    v_lshl_add_u32 v6, v4, 3, v5
    v_lshlrev_b32 v6, 8, v6
    v_and_b32 v7, 3, v1
    v_lshl_add_u32 v6, v7, 3, v6
    v_and_b32 v7, 1, v4
    v_lshl_or_b32 v5, v7, 2, v5
    s_cmp_eq_u32 s37, 1
    s_cselect_b32 s3, 4, 0
    s_cselect_b32 s4, 0, 0
    s_lshl_b32 s4, s4, 14
    s_add_u32 s4, s4, 32768
    s_cmp_eq_u32 s37, 1
    v_xor_b32 v7, s3, v5
    v_lshl_add_u32 v7, v7, 5, v6
    v_add_u32 v18, s4, v7
    v_add_u32 v120, 65536, v18
    s_cselect_b32 s3, 5, 1
    s_cselect_b32 s4, 0, 0
    s_lshl_b32 s4, s4, 14
    s_add_u32 s4, s4, 32768
    s_cmp_eq_u32 s37, 1
    v_xor_b32 v7, s3, v5
    v_lshl_add_u32 v7, v7, 5, v6
    v_add_u32 v19, s4, v7
    v_add_u32 v121, 65536, v19
    s_cselect_b32 s3, 6, 2
    s_cselect_b32 s4, 0, 0
    s_lshl_b32 s4, s4, 14
    s_add_u32 s4, s4, 32768
    s_cmp_eq_u32 s37, 1
    v_xor_b32 v7, s3, v5
    v_lshl_add_u32 v7, v7, 5, v6
    v_add_u32 v20, s4, v7
    v_add_u32 v122, 65536, v20
    s_cselect_b32 s3, 4, 0
    s_cselect_b32 s4, 1, 1
    s_lshl_b32 s4, s4, 14
    s_add_u32 s4, s4, 32768
    s_cmp_eq_u32 s37, 1
    v_xor_b32 v7, s3, v5
    v_lshl_add_u32 v7, v7, 5, v6
    v_add_u32 v21, s4, v7
    v_add_u32 v123, 65536, v21
    s_cselect_b32 s3, 5, 1
    s_cselect_b32 s4, 1, 1
    s_lshl_b32 s4, s4, 14
    s_add_u32 s4, s4, 32768
    s_cmp_eq_u32 s37, 1
    v_xor_b32 v7, s3, v5
    v_lshl_add_u32 v7, v7, 5, v6
    v_add_u32 v22, s4, v7
    v_add_u32 v124, 65536, v22
    s_cselect_b32 s3, 6, 2
    s_cselect_b32 s4, 1, 1
    s_lshl_b32 s4, s4, 14
    s_add_u32 s4, s4, 32768
    s_cmp_eq_u32 s37, 1
    v_xor_b32 v7, s3, v5
    v_lshl_add_u32 v7, v7, 5, v6
    v_add_u32 v23, s4, v7
    v_add_u32 v125, 65536, v23
    s_cselect_b32 s3, 3, 3
    s_cselect_b32 s4, 1, 0
    s_lshl_b32 s4, s4, 14
    s_add_u32 s4, s4, 32768
    s_cmp_eq_u32 s37, 1
    v_xor_b32 v7, s3, v5
    v_lshl_add_u32 v7, v7, 5, v6
    v_add_u32 v24, s4, v7
    v_add_u32 v126, 65536, v24
    v_mov_b32 v128, 0
    v_mov_b32 v129, 0
    v_mov_b32 v130, 0
    v_mov_b32 v131, 0
    v_mov_b32 v132, 0
    v_mov_b32 v133, 0
    v_mov_b32 v134, 0
    v_mov_b32 v135, 0
    v_mov_b32 v136, 0
    v_mov_b32 v137, 0
    v_mov_b32 v138, 0
    v_mov_b32 v139, 0
    v_mov_b32 v140, 0
    v_mov_b32 v141, 0
    v_mov_b32 v142, 0
    v_mov_b32 v143, 0
    v_mov_b32 v144, 0
    v_mov_b32 v145, 0
    v_mov_b32 v146, 0
    v_mov_b32 v147, 0
    v_mov_b32 v148, 0
    v_mov_b32 v149, 0
    v_mov_b32 v150, 0
    v_mov_b32 v151, 0
    v_mov_b32 v152, 0
    v_mov_b32 v153, 0
    v_mov_b32 v154, 0
    v_mov_b32 v155, 0
    v_mov_b32 v156, 0
    v_mov_b32 v157, 0
    v_mov_b32 v158, 0
    v_mov_b32 v159, 0
    v_mov_b32 v160, 0
    v_mov_b32 v161, 0
    v_mov_b32 v162, 0
    v_mov_b32 v163, 0
    v_mov_b32 v164, 0
    v_mov_b32 v165, 0
    v_mov_b32 v166, 0
    v_mov_b32 v167, 0
    v_mov_b32 v168, 0
    v_mov_b32 v169, 0
    v_mov_b32 v170, 0
    v_mov_b32 v171, 0
    v_mov_b32 v172, 0
    v_mov_b32 v173, 0
    v_mov_b32 v174, 0
    v_mov_b32 v175, 0
    v_mov_b32 v176, 0
    v_mov_b32 v177, 0
    v_mov_b32 v178, 0
    v_mov_b32 v179, 0
    v_mov_b32 v180, 0
    v_mov_b32 v181, 0
    v_mov_b32 v182, 0
    v_mov_b32 v183, 0
    v_mov_b32 v184, 0
    v_mov_b32 v185, 0
    v_mov_b32 v186, 0
    v_mov_b32 v187, 0
    v_mov_b32 v188, 0
    v_mov_b32 v189, 0
    v_mov_b32 v190, 0
    v_mov_b32 v191, 0
    v_mov_b32 v192, 0
    v_mov_b32 v193, 0
    v_mov_b32 v194, 0
    v_mov_b32 v195, 0
    v_mov_b32 v196, 0
    v_mov_b32 v197, 0
    v_mov_b32 v198, 0
    v_mov_b32 v199, 0
    v_mov_b32 v200, 0
    v_mov_b32 v201, 0
    v_mov_b32 v202, 0
    v_mov_b32 v203, 0
    v_mov_b32 v204, 0
    v_mov_b32 v205, 0
    v_mov_b32 v206, 0
    v_mov_b32 v207, 0
    v_mov_b32 v208, 0
    v_mov_b32 v209, 0
    v_mov_b32 v210, 0
    v_mov_b32 v211, 0
    v_mov_b32 v212, 0
    v_mov_b32 v213, 0
    v_mov_b32 v214, 0
    v_mov_b32 v215, 0
    v_mov_b32 v216, 0
    v_mov_b32 v217, 0
    v_mov_b32 v218, 0
    v_mov_b32 v219, 0
    v_mov_b32 v220, 0
    v_mov_b32 v221, 0
    v_mov_b32 v222, 0
    v_mov_b32 v223, 0
    v_mov_b32 v224, 0
    v_mov_b32 v225, 0
    v_mov_b32 v226, 0
    v_mov_b32 v227, 0
    v_mov_b32 v228, 0
    v_mov_b32 v229, 0
    v_mov_b32 v230, 0
    v_mov_b32 v231, 0
    v_mov_b32 v232, 0
    v_mov_b32 v233, 0
    v_mov_b32 v234, 0
    v_mov_b32 v235, 0
    v_mov_b32 v236, 0
    v_mov_b32 v237, 0
    v_mov_b32 v238, 0
    v_mov_b32 v239, 0
    s_waitcnt vmcnt(8)
    s_barrier
    ds_read_b128 v[32:35], v14 offset:0
    ds_read_b128 v[36:39], v14 offset:2048
    ds_read_b128 v[40:43], v14 offset:4096
    ds_read_b128 v[44:47], v14 offset:6144
    ds_read_b64_tr_b16 v[48:49], v18 offset:0
    ds_read_b64_tr_b16 v[50:51], v18 offset:1024
    ds_read_b64_tr_b16 v[52:53], v19 offset:0
    ds_read_b64_tr_b16 v[54:55], v19 offset:1024
    ds_read_b64_tr_b16 v[56:57], v20 offset:0
    ds_read_b64_tr_b16 v[58:59], v20 offset:1024
    ds_read_b64_tr_b16 v[60:61], v21 offset:0
    ds_read_b64_tr_b16 v[62:63], v21 offset:1024
    ds_read_b64_tr_b16 v[64:65], v22 offset:0
    ds_read_b64_tr_b16 v[66:67], v22 offset:1024
    ds_read_b64_tr_b16 v[68:69], v23 offset:0
    ds_read_b64_tr_b16 v[70:71], v23 offset:1024
    ds_read_b64_tr_b16 v[72:73], v24 offset:0
    ds_read_b64_tr_b16 v[74:75], v24 offset:1024
    s_mov_b32 s26, 0
K4_LOOP:
    s_waitcnt lgkmcnt(0)
    v_mfma_f32_16x16x32_bf16 v[128:131], v[48:51], v[32:35], v[128:131]
    ds_read_b128 v[76:79], v15 offset:0
    v_mfma_f32_16x16x32_bf16 v[156:159], v[48:51], v[36:39], v[156:159]
    ds_read_b128 v[80:83], v15 offset:2048
    v_mfma_f32_16x16x32_bf16 v[184:187], v[48:51], v[40:43], v[184:187]
    ds_read_b128 v[84:87], v15 offset:4096
    v_mfma_f32_16x16x32_bf16 v[212:215], v[48:51], v[44:47], v[212:215]
    ds_read_b128 v[88:91], v15 offset:6144
    v_mfma_f32_16x16x32_bf16 v[132:135], v[52:55], v[32:35], v[132:135]
    ds_read_b64_tr_b16 v[92:93], v18 offset:8192
    v_mfma_f32_16x16x32_bf16 v[160:163], v[52:55], v[36:39], v[160:163]
    ds_read_b64_tr_b16 v[94:95], v18 offset:9216
    v_mfma_f32_16x16x32_bf16 v[188:191], v[52:55], v[40:43], v[188:191]
    ds_read_b64_tr_b16 v[96:97], v19 offset:8192
    v_mfma_f32_16x16x32_bf16 v[216:219], v[52:55], v[44:47], v[216:219]
    ds_read_b64_tr_b16 v[98:99], v19 offset:9216
    v_mfma_f32_16x16x32_bf16 v[136:139], v[56:59], v[32:35], v[136:139]
    ds_read_b64_tr_b16 v[100:101], v20 offset:8192
    v_mfma_f32_16x16x32_bf16 v[164:167], v[56:59], v[36:39], v[164:167]
    ds_read_b64_tr_b16 v[102:103], v20 offset:9216
    v_mfma_f32_16x16x32_bf16 v[192:195], v[56:59], v[40:43], v[192:195]
    ds_read_b64_tr_b16 v[104:105], v21 offset:8192
    v_mfma_f32_16x16x32_bf16 v[220:223], v[56:59], v[44:47], v[220:223]
    ds_read_b64_tr_b16 v[106:107], v21 offset:9216
    v_mfma_f32_16x16x32_bf16 v[140:143], v[60:63], v[32:35], v[140:143]
    ds_read_b64_tr_b16 v[108:109], v22 offset:8192
    v_mfma_f32_16x16x32_bf16 v[168:171], v[60:63], v[36:39], v[168:171]
    ds_read_b64_tr_b16 v[110:111], v22 offset:9216
    v_mfma_f32_16x16x32_bf16 v[196:199], v[60:63], v[40:43], v[196:199]
    ds_read_b64_tr_b16 v[112:113], v23 offset:8192
    v_mfma_f32_16x16x32_bf16 v[224:227], v[60:63], v[44:47], v[224:227]
    ds_read_b64_tr_b16 v[114:115], v23 offset:9216
    v_mfma_f32_16x16x32_bf16 v[144:147], v[64:67], v[32:35], v[144:147]
    ds_read_b64_tr_b16 v[116:117], v24 offset:8192
    v_mfma_f32_16x16x32_bf16 v[172:175], v[64:67], v[36:39], v[172:175]
    ds_read_b64_tr_b16 v[118:119], v24 offset:9216
    v_mfma_f32_16x16x32_bf16 v[200:203], v[64:67], v[40:43], v[200:203]
    v_mfma_f32_16x16x32_bf16 v[228:231], v[64:67], v[44:47], v[228:231]
    v_mfma_f32_16x16x32_bf16 v[148:151], v[68:71], v[32:35], v[148:151]
    v_mfma_f32_16x16x32_bf16 v[176:179], v[68:71], v[36:39], v[176:179]
    v_mfma_f32_16x16x32_bf16 v[204:207], v[68:71], v[40:43], v[204:207]
    v_mfma_f32_16x16x32_bf16 v[232:235], v[68:71], v[44:47], v[232:235]
    v_mfma_f32_16x16x32_bf16 v[152:155], v[72:75], v[32:35], v[152:155]
    v_mfma_f32_16x16x32_bf16 v[180:183], v[72:75], v[36:39], v[180:183]
    v_mfma_f32_16x16x32_bf16 v[208:211], v[72:75], v[40:43], v[208:211]
    v_mfma_f32_16x16x32_bf16 v[236:239], v[72:75], v[44:47], v[236:239]
    s_waitcnt vmcnt(0) lgkmcnt(0)
    s_barrier
    v_mfma_f32_16x16x32_bf16 v[128:131], v[92:95], v[76:79], v[128:131]
    ds_read_b128 v[32:35], v16 offset:0
    v_mfma_f32_16x16x32_bf16 v[156:159], v[92:95], v[80:83], v[156:159]
    ds_read_b128 v[36:39], v16 offset:2048
    v_mfma_f32_16x16x32_bf16 v[184:187], v[92:95], v[84:87], v[184:187]
    s_add_u32 m0, s30, 0
    s_add_u32 s33, s24, 0
    buffer_load_dwordx4 v10, s[8:11], s33 offen lds
    v_mfma_f32_16x16x32_bf16 v[212:215], v[92:95], v[88:91], v[212:215]
    ds_read_b128 v[40:43], v16 offset:4096
    v_mfma_f32_16x16x32_bf16 v[132:135], v[96:99], v[76:79], v[132:135]
    ds_read_b128 v[44:47], v16 offset:6144
    v_mfma_f32_16x16x32_bf16 v[160:163], v[96:99], v[80:83], v[160:163]
    s_add_u32 m0, s30, 1024
    s_add_u32 s33, s24, 16384
    buffer_load_dwordx4 v10, s[8:11], s33 offen lds
    v_mfma_f32_16x16x32_bf16 v[188:191], v[96:99], v[84:87], v[188:191]
    ds_read_b64_tr_b16 v[48:49], v120 offset:0
    v_mfma_f32_16x16x32_bf16 v[216:219], v[96:99], v[88:91], v[216:219]
    ds_read_b64_tr_b16 v[50:51], v120 offset:1024
    v_mfma_f32_16x16x32_bf16 v[136:139], v[100:103], v[76:79], v[136:139]
    s_add_u32 m0, s30, 2048
    s_add_u32 s33, s24, 32768
    buffer_load_dwordx4 v10, s[8:11], s33 offen lds
    v_mfma_f32_16x16x32_bf16 v[164:167], v[100:103], v[80:83], v[164:167]
    ds_read_b64_tr_b16 v[52:53], v121 offset:0
    v_mfma_f32_16x16x32_bf16 v[192:195], v[100:103], v[84:87], v[192:195]
    ds_read_b64_tr_b16 v[54:55], v121 offset:1024
    v_mfma_f32_16x16x32_bf16 v[220:223], v[100:103], v[88:91], v[220:223]
    s_add_u32 m0, s30, 3072
    s_add_u32 s33, s24, 49152
    buffer_load_dwordx4 v10, s[8:11], s33 offen lds
    v_mfma_f32_16x16x32_bf16 v[140:143], v[104:107], v[76:79], v[140:143]
    ds_read_b64_tr_b16 v[56:57], v122 offset:0
    v_mfma_f32_16x16x32_bf16 v[168:171], v[104:107], v[80:83], v[168:171]
    ds_read_b64_tr_b16 v[58:59], v122 offset:1024
    v_mfma_f32_16x16x32_bf16 v[196:199], v[104:107], v[84:87], v[196:199]
    s_add_u32 m0, s31, 0
    s_add_u32 s33, s25, 0
    s_mov_b64 exec, s[40:41]
    buffer_load_dwordx4 v11, s[12:15], s33 offen lds
    s_mov_b64 exec, -1
    v_mfma_f32_16x16x32_bf16 v[224:227], v[104:107], v[88:91], v[224:227]
    ds_read_b64_tr_b16 v[60:61], v123 offset:0
    v_mfma_f32_16x16x32_bf16 v[144:147], v[108:111], v[76:79], v[144:147]
    ds_read_b64_tr_b16 v[62:63], v123 offset:1024
    v_mfma_f32_16x16x32_bf16 v[172:175], v[108:111], v[80:83], v[172:175]
    s_add_u32 m0, s31, 1024
    s_add_u32 s33, s25, 28672
    s_mov_b64 exec, s[40:41]
    buffer_load_dwordx4 v11, s[12:15], s33 offen lds
    s_mov_b64 exec, -1
    v_mfma_f32_16x16x32_bf16 v[200:203], v[108:111], v[84:87], v[200:203]
    ds_read_b64_tr_b16 v[64:65], v124 offset:0
    v_mfma_f32_16x16x32_bf16 v[228:231], v[108:111], v[88:91], v[228:231]
    ds_read_b64_tr_b16 v[66:67], v124 offset:1024
    v_mfma_f32_16x16x32_bf16 v[148:151], v[112:115], v[76:79], v[148:151]
    s_add_u32 m0, s31, 2048
    s_add_u32 s33, s25, 57344
    s_mov_b64 exec, s[42:43]
    buffer_load_dwordx4 v12, s[12:15], s33 offen lds
    s_mov_b64 exec, -1
    v_mfma_f32_16x16x32_bf16 v[176:179], v[112:115], v[80:83], v[176:179]
    ds_read_b64_tr_b16 v[68:69], v125 offset:0
    v_mfma_f32_16x16x32_bf16 v[204:207], v[112:115], v[84:87], v[204:207]
    ds_read_b64_tr_b16 v[70:71], v125 offset:1024
    v_mfma_f32_16x16x32_bf16 v[232:235], v[112:115], v[88:91], v[232:235]
    s_add_u32 m0, s31, 3072
    s_add_u32 s33, s25, 86016
    s_mov_b64 exec, s[42:43]
    buffer_load_dwordx4 v12, s[12:15], s33 offen lds
    s_mov_b64 exec, -1
    v_mfma_f32_16x16x32_bf16 v[152:155], v[116:119], v[76:79], v[152:155]
    ds_read_b64_tr_b16 v[72:73], v126 offset:0
    v_mfma_f32_16x16x32_bf16 v[180:183], v[116:119], v[80:83], v[180:183]
    ds_read_b64_tr_b16 v[74:75], v126 offset:1024
    v_mfma_f32_16x16x32_bf16 v[208:211], v[116:119], v[84:87], v[208:211]
    s_add_u32 s24, s24, 128
    s_add_u32 s25, s25, 458752
    v_mfma_f32_16x16x32_bf16 v[236:239], v[116:119], v[88:91], v[236:239]
    s_waitcnt lgkmcnt(0)
    v_mfma_f32_16x16x32_bf16 v[128:131], v[48:51], v[32:35], v[128:131]
    ds_read_b128 v[76:79], v17 offset:0
    v_mfma_f32_16x16x32_bf16 v[156:159], v[48:51], v[36:39], v[156:159]
    ds_read_b128 v[80:83], v17 offset:2048
    v_mfma_f32_16x16x32_bf16 v[184:187], v[48:51], v[40:43], v[184:187]
    ds_read_b128 v[84:87], v17 offset:4096
    v_mfma_f32_16x16x32_bf16 v[212:215], v[48:51], v[44:47], v[212:215]
    ds_read_b128 v[88:91], v17 offset:6144
    v_mfma_f32_16x16x32_bf16 v[132:135], v[52:55], v[32:35], v[132:135]
    ds_read_b64_tr_b16 v[92:93], v120 offset:8192
    v_mfma_f32_16x16x32_bf16 v[160:163], v[52:55], v[36:39], v[160:163]
    ds_read_b64_tr_b16 v[94:95], v120 offset:9216
    v_mfma_f32_16x16x32_bf16 v[188:191], v[52:55], v[40:43], v[188:191]
    ds_read_b64_tr_b16 v[96:97], v121 offset:8192
    v_mfma_f32_16x16x32_bf16 v[216:219], v[52:55], v[44:47], v[216:219]
    ds_read_b64_tr_b16 v[98:99], v121 offset:9216
    v_mfma_f32_16x16x32_bf16 v[136:139], v[56:59], v[32:35], v[136:139]
    ds_read_b64_tr_b16 v[100:101], v122 offset:8192
    v_mfma_f32_16x16x32_bf16 v[164:167], v[56:59], v[36:39], v[164:167]
    ds_read_b64_tr_b16 v[102:103], v122 offset:9216
    v_mfma_f32_16x16x32_bf16 v[192:195], v[56:59], v[40:43], v[192:195]
    ds_read_b64_tr_b16 v[104:105], v123 offset:8192
    v_mfma_f32_16x16x32_bf16 v[220:223], v[56:59], v[44:47], v[220:223]
    ds_read_b64_tr_b16 v[106:107], v123 offset:9216
    v_mfma_f32_16x16x32_bf16 v[140:143], v[60:63], v[32:35], v[140:143]
    ds_read_b64_tr_b16 v[108:109], v124 offset:8192
    v_mfma_f32_16x16x32_bf16 v[168:171], v[60:63], v[36:39], v[168:171]
    ds_read_b64_tr_b16 v[110:111], v124 offset:9216
    v_mfma_f32_16x16x32_bf16 v[196:199], v[60:63], v[40:43], v[196:199]
    ds_read_b64_tr_b16 v[112:113], v125 offset:8192
    v_mfma_f32_16x16x32_bf16 v[224:227], v[60:63], v[44:47], v[224:227]
    ds_read_b64_tr_b16 v[114:115], v125 offset:9216
    v_mfma_f32_16x16x32_bf16 v[144:147], v[64:67], v[32:35], v[144:147]
    ds_read_b64_tr_b16 v[116:117], v126 offset:8192
    v_mfma_f32_16x16x32_bf16 v[172:175], v[64:67], v[36:39], v[172:175]
    ds_read_b64_tr_b16 v[118:119], v126 offset:9216
    v_mfma_f32_16x16x32_bf16 v[200:203], v[64:67], v[40:43], v[200:203]
    v_mfma_f32_16x16x32_bf16 v[228:231], v[64:67], v[44:47], v[228:231]
    v_mfma_f32_16x16x32_bf16 v[148:151], v[68:71], v[32:35], v[148:151]
    v_mfma_f32_16x16x32_bf16 v[176:179], v[68:71], v[36:39], v[176:179]
    v_mfma_f32_16x16x32_bf16 v[204:207], v[68:71], v[40:43], v[204:207]
    v_mfma_f32_16x16x32_bf16 v[232:235], v[68:71], v[44:47], v[232:235]
    v_mfma_f32_16x16x32_bf16 v[152:155], v[72:75], v[32:35], v[152:155]
    v_mfma_f32_16x16x32_bf16 v[180:183], v[72:75], v[36:39], v[180:183]
    v_mfma_f32_16x16x32_bf16 v[208:211], v[72:75], v[40:43], v[208:211]
    v_mfma_f32_16x16x32_bf16 v[236:239], v[72:75], v[44:47], v[236:239]
    s_waitcnt vmcnt(0) lgkmcnt(0)
    s_barrier
    v_mfma_f32_16x16x32_bf16 v[128:131], v[92:95], v[76:79], v[128:131]
    ds_read_b128 v[32:35], v14 offset:0
    v_mfma_f32_16x16x32_bf16 v[156:159], v[92:95], v[80:83], v[156:159]
    ds_read_b128 v[36:39], v14 offset:2048
    v_mfma_f32_16x16x32_bf16 v[184:187], v[92:95], v[84:87], v[184:187]
    s_add_u32 m0, s30, 65536
    s_add_u32 s33, s24, 0
    buffer_load_dwordx4 v10, s[8:11], s33 offen lds
    v_mfma_f32_16x16x32_bf16 v[212:215], v[92:95], v[88:91], v[212:215]
    ds_read_b128 v[40:43], v14 offset:4096
    v_mfma_f32_16x16x32_bf16 v[132:135], v[96:99], v[76:79], v[132:135]
    ds_read_b128 v[44:47], v14 offset:6144
    v_mfma_f32_16x16x32_bf16 v[160:163], v[96:99], v[80:83], v[160:163]
    s_add_u32 m0, s30, 66560
    s_add_u32 s33, s24, 16384
    buffer_load_dwordx4 v10, s[8:11], s33 offen lds
    v_mfma_f32_16x16x32_bf16 v[188:191], v[96:99], v[84:87], v[188:191]
    ds_read_b64_tr_b16 v[48:49], v18 offset:0
    v_mfma_f32_16x16x32_bf16 v[216:219], v[96:99], v[88:91], v[216:219]
    ds_read_b64_tr_b16 v[50:51], v18 offset:1024
    v_mfma_f32_16x16x32_bf16 v[136:139], v[100:103], v[76:79], v[136:139]
    s_add_u32 m0, s30, 67584
    s_add_u32 s33, s24, 32768
    buffer_load_dwordx4 v10, s[8:11], s33 offen lds
    v_mfma_f32_16x16x32_bf16 v[164:167], v[100:103], v[80:83], v[164:167]
    ds_read_b64_tr_b16 v[52:53], v19 offset:0
    v_mfma_f32_16x16x32_bf16 v[192:195], v[100:103], v[84:87], v[192:195]
    ds_read_b64_tr_b16 v[54:55], v19 offset:1024
    v_mfma_f32_16x16x32_bf16 v[220:223], v[100:103], v[88:91], v[220:223]
    s_add_u32 m0, s30, 68608
    s_add_u32 s33, s24, 49152
    buffer_load_dwordx4 v10, s[8:11], s33 offen lds
    v_mfma_f32_16x16x32_bf16 v[140:143], v[104:107], v[76:79], v[140:143]
    ds_read_b64_tr_b16 v[56:57], v20 offset:0
    v_mfma_f32_16x16x32_bf16 v[168:171], v[104:107], v[80:83], v[168:171]
    ds_read_b64_tr_b16 v[58:59], v20 offset:1024
    v_mfma_f32_16x16x32_bf16 v[196:199], v[104:107], v[84:87], v[196:199]
    s_add_u32 m0, s31, 65536
    s_add_u32 s33, s25, 0
    s_mov_b64 exec, s[40:41]
    buffer_load_dwordx4 v11, s[12:15], s33 offen lds
    s_mov_b64 exec, -1
    v_mfma_f32_16x16x32_bf16 v[224:227], v[104:107], v[88:91], v[224:227]
    ds_read_b64_tr_b16 v[60:61], v21 offset:0
    v_mfma_f32_16x16x32_bf16 v[144:147], v[108:111], v[76:79], v[144:147]
    ds_read_b64_tr_b16 v[62:63], v21 offset:1024
    v_mfma_f32_16x16x32_bf16 v[172:175], v[108:111], v[80:83], v[172:175]
    s_add_u32 m0, s31, 66560
    s_add_u32 s33, s25, 28672
    s_mov_b64 exec, s[40:41]
    buffer_load_dwordx4 v11, s[12:15], s33 offen lds
    s_mov_b64 exec, -1
    v_mfma_f32_16x16x32_bf16 v[200:203], v[108:111], v[84:87], v[200:203]
    ds_read_b64_tr_b16 v[64:65], v22 offset:0
    v_mfma_f32_16x16x32_bf16 v[228:231], v[108:111], v[88:91], v[228:231]
    ds_read_b64_tr_b16 v[66:67], v22 offset:1024
    v_mfma_f32_16x16x32_bf16 v[148:151], v[112:115], v[76:79], v[148:151]
    s_add_u32 m0, s31, 67584
    s_add_u32 s33, s25, 57344
    s_mov_b64 exec, s[42:43]
    buffer_load_dwordx4 v12, s[12:15], s33 offen lds
    s_mov_b64 exec, -1
    v_mfma_f32_16x16x32_bf16 v[176:179], v[112:115], v[80:83], v[176:179]
    ds_read_b64_tr_b16 v[68:69], v23 offset:0
    v_mfma_f32_16x16x32_bf16 v[204:207], v[112:115], v[84:87], v[204:207]
    ds_read_b64_tr_b16 v[70:71], v23 offset:1024
    v_mfma_f32_16x16x32_bf16 v[232:235], v[112:115], v[88:91], v[232:235]
    s_add_u32 m0, s31, 68608
    s_add_u32 s33, s25, 86016
    s_mov_b64 exec, s[42:43]
    buffer_load_dwordx4 v12, s[12:15], s33 offen lds
    s_mov_b64 exec, -1
    v_mfma_f32_16x16x32_bf16 v[152:155], v[116:119], v[76:79], v[152:155]
    ds_read_b64_tr_b16 v[72:73], v24 offset:0
    v_mfma_f32_16x16x32_bf16 v[180:183], v[116:119], v[80:83], v[180:183]
    ds_read_b64_tr_b16 v[74:75], v24 offset:1024
    v_mfma_f32_16x16x32_bf16 v[208:211], v[116:119], v[84:87], v[208:211]
    s_add_u32 s24, s24, 128
    s_add_u32 s25, s25, 458752
    v_mfma_f32_16x16x32_bf16 v[236:239], v[116:119], v[88:91], v[236:239]
    s_add_u32 s26, s26, 1
    s_cmp_lt_u32 s26, 7
    s_cbranch_scc1 K4_LOOP
    s_waitcnt lgkmcnt(0)
    v_mfma_f32_16x16x32_bf16 v[128:131], v[48:51], v[32:35], v[128:131]
    ds_read_b128 v[76:79], v15 offset:0
    v_mfma_f32_16x16x32_bf16 v[156:159], v[48:51], v[36:39], v[156:159]
    ds_read_b128 v[80:83], v15 offset:2048
    v_mfma_f32_16x16x32_bf16 v[184:187], v[48:51], v[40:43], v[184:187]
    ds_read_b128 v[84:87], v15 offset:4096
    v_mfma_f32_16x16x32_bf16 v[212:215], v[48:51], v[44:47], v[212:215]
    ds_read_b128 v[88:91], v15 offset:6144
    v_mfma_f32_16x16x32_bf16 v[132:135], v[52:55], v[32:35], v[132:135]
    ds_read_b64_tr_b16 v[92:93], v18 offset:8192
    v_mfma_f32_16x16x32_bf16 v[160:163], v[52:55], v[36:39], v[160:163]
    ds_read_b64_tr_b16 v[94:95], v18 offset:9216
    v_mfma_f32_16x16x32_bf16 v[188:191], v[52:55], v[40:43], v[188:191]
    ds_read_b64_tr_b16 v[96:97], v19 offset:8192
    v_mfma_f32_16x16x32_bf16 v[216:219], v[52:55], v[44:47], v[216:219]
    ds_read_b64_tr_b16 v[98:99], v19 offset:9216
    v_mfma_f32_16x16x32_bf16 v[136:139], v[56:59], v[32:35], v[136:139]
    ds_read_b64_tr_b16 v[100:101], v20 offset:8192
    v_mfma_f32_16x16x32_bf16 v[164:167], v[56:59], v[36:39], v[164:167]
    ds_read_b64_tr_b16 v[102:103], v20 offset:9216
    v_mfma_f32_16x16x32_bf16 v[192:195], v[56:59], v[40:43], v[192:195]
    ds_read_b64_tr_b16 v[104:105], v21 offset:8192
    v_mfma_f32_16x16x32_bf16 v[220:223], v[56:59], v[44:47], v[220:223]
    ds_read_b64_tr_b16 v[106:107], v21 offset:9216
    v_mfma_f32_16x16x32_bf16 v[140:143], v[60:63], v[32:35], v[140:143]
    ds_read_b64_tr_b16 v[108:109], v22 offset:8192
    v_mfma_f32_16x16x32_bf16 v[168:171], v[60:63], v[36:39], v[168:171]
    ds_read_b64_tr_b16 v[110:111], v22 offset:9216
    v_mfma_f32_16x16x32_bf16 v[196:199], v[60:63], v[40:43], v[196:199]
    ds_read_b64_tr_b16 v[112:113], v23 offset:8192
    v_mfma_f32_16x16x32_bf16 v[224:227], v[60:63], v[44:47], v[224:227]
    ds_read_b64_tr_b16 v[114:115], v23 offset:9216
    v_mfma_f32_16x16x32_bf16 v[144:147], v[64:67], v[32:35], v[144:147]
    ds_read_b64_tr_b16 v[116:117], v24 offset:8192
    v_mfma_f32_16x16x32_bf16 v[172:175], v[64:67], v[36:39], v[172:175]
    ds_read_b64_tr_b16 v[118:119], v24 offset:9216
    v_mfma_f32_16x16x32_bf16 v[200:203], v[64:67], v[40:43], v[200:203]
    v_mfma_f32_16x16x32_bf16 v[228:231], v[64:67], v[44:47], v[228:231]
    v_mfma_f32_16x16x32_bf16 v[148:151], v[68:71], v[32:35], v[148:151]
    v_mfma_f32_16x16x32_bf16 v[176:179], v[68:71], v[36:39], v[176:179]
    v_mfma_f32_16x16x32_bf16 v[204:207], v[68:71], v[40:43], v[204:207]
    v_mfma_f32_16x16x32_bf16 v[232:235], v[68:71], v[44:47], v[232:235]
    v_mfma_f32_16x16x32_bf16 v[152:155], v[72:75], v[32:35], v[152:155]
    v_mfma_f32_16x16x32_bf16 v[180:183], v[72:75], v[36:39], v[180:183]
    v_mfma_f32_16x16x32_bf16 v[208:211], v[72:75], v[40:43], v[208:211]
    v_mfma_f32_16x16x32_bf16 v[236:239], v[72:75], v[44:47], v[236:239]
    s_waitcnt vmcnt(0) lgkmcnt(0)
    s_barrier
    v_mfma_f32_16x16x32_bf16 v[128:131], v[92:95], v[76:79], v[128:131]
    ds_read_b128 v[32:35], v16 offset:0
    v_mfma_f32_16x16x32_bf16 v[156:159], v[92:95], v[80:83], v[156:159]
    ds_read_b128 v[36:39], v16 offset:2048
    v_mfma_f32_16x16x32_bf16 v[184:187], v[92:95], v[84:87], v[184:187]
    ds_read_b128 v[40:43], v16 offset:4096
    v_mfma_f32_16x16x32_bf16 v[212:215], v[92:95], v[88:91], v[212:215]
    ds_read_b128 v[44:47], v16 offset:6144
    v_mfma_f32_16x16x32_bf16 v[132:135], v[96:99], v[76:79], v[132:135]
    ds_read_b64_tr_b16 v[48:49], v120 offset:0
    v_mfma_f32_16x16x32_bf16 v[160:163], v[96:99], v[80:83], v[160:163]
    ds_read_b64_tr_b16 v[50:51], v120 offset:1024
    v_mfma_f32_16x16x32_bf16 v[188:191], v[96:99], v[84:87], v[188:191]
    ds_read_b64_tr_b16 v[52:53], v121 offset:0
    v_mfma_f32_16x16x32_bf16 v[216:219], v[96:99], v[88:91], v[216:219]
    ds_read_b64_tr_b16 v[54:55], v121 offset:1024
    v_mfma_f32_16x16x32_bf16 v[136:139], v[100:103], v[76:79], v[136:139]
    ds_read_b64_tr_b16 v[56:57], v122 offset:0
    v_mfma_f32_16x16x32_bf16 v[164:167], v[100:103], v[80:83], v[164:167]
    ds_read_b64_tr_b16 v[58:59], v122 offset:1024
    v_mfma_f32_16x16x32_bf16 v[192:195], v[100:103], v[84:87], v[192:195]
    ds_read_b64_tr_b16 v[60:61], v123 offset:0
    v_mfma_f32_16x16x32_bf16 v[220:223], v[100:103], v[88:91], v[220:223]
    ds_read_b64_tr_b16 v[62:63], v123 offset:1024
    v_mfma_f32_16x16x32_bf16 v[140:143], v[104:107], v[76:79], v[140:143]
    ds_read_b64_tr_b16 v[64:65], v124 offset:0
    v_mfma_f32_16x16x32_bf16 v[168:171], v[104:107], v[80:83], v[168:171]
    ds_read_b64_tr_b16 v[66:67], v124 offset:1024
    v_mfma_f32_16x16x32_bf16 v[196:199], v[104:107], v[84:87], v[196:199]
    ds_read_b64_tr_b16 v[68:69], v125 offset:0
    v_mfma_f32_16x16x32_bf16 v[224:227], v[104:107], v[88:91], v[224:227]
    ds_read_b64_tr_b16 v[70:71], v125 offset:1024
    v_mfma_f32_16x16x32_bf16 v[144:147], v[108:111], v[76:79], v[144:147]
    ds_read_b64_tr_b16 v[72:73], v126 offset:0
    v_mfma_f32_16x16x32_bf16 v[172:175], v[108:111], v[80:83], v[172:175]
    ds_read_b64_tr_b16 v[74:75], v126 offset:1024
    v_mfma_f32_16x16x32_bf16 v[200:203], v[108:111], v[84:87], v[200:203]
    v_mfma_f32_16x16x32_bf16 v[228:231], v[108:111], v[88:91], v[228:231]
    v_mfma_f32_16x16x32_bf16 v[148:151], v[112:115], v[76:79], v[148:151]
    v_mfma_f32_16x16x32_bf16 v[176:179], v[112:115], v[80:83], v[176:179]
    v_mfma_f32_16x16x32_bf16 v[204:207], v[112:115], v[84:87], v[204:207]
    v_mfma_f32_16x16x32_bf16 v[232:235], v[112:115], v[88:91], v[232:235]
    v_mfma_f32_16x16x32_bf16 v[152:155], v[116:119], v[76:79], v[152:155]
    v_mfma_f32_16x16x32_bf16 v[180:183], v[116:119], v[80:83], v[180:183]
    v_mfma_f32_16x16x32_bf16 v[208:211], v[116:119], v[84:87], v[208:211]
    v_mfma_f32_16x16x32_bf16 v[236:239], v[116:119], v[88:91], v[236:239]
    s_waitcnt lgkmcnt(0)
    v_mfma_f32_16x16x32_bf16 v[128:131], v[48:51], v[32:35], v[128:131]
    ds_read_b128 v[76:79], v17 offset:0
    v_mfma_f32_16x16x32_bf16 v[156:159], v[48:51], v[36:39], v[156:159]
    ds_read_b128 v[80:83], v17 offset:2048
    v_mfma_f32_16x16x32_bf16 v[184:187], v[48:51], v[40:43], v[184:187]
    ds_read_b128 v[84:87], v17 offset:4096
    v_mfma_f32_16x16x32_bf16 v[212:215], v[48:51], v[44:47], v[212:215]
    ds_read_b128 v[88:91], v17 offset:6144
    v_mfma_f32_16x16x32_bf16 v[132:135], v[52:55], v[32:35], v[132:135]
    ds_read_b64_tr_b16 v[92:93], v120 offset:8192
    v_mfma_f32_16x16x32_bf16 v[160:163], v[52:55], v[36:39], v[160:163]
    ds_read_b64_tr_b16 v[94:95], v120 offset:9216
    v_mfma_f32_16x16x32_bf16 v[188:191], v[52:55], v[40:43], v[188:191]
    ds_read_b64_tr_b16 v[96:97], v121 offset:8192
    v_mfma_f32_16x16x32_bf16 v[216:219], v[52:55], v[44:47], v[216:219]
    ds_read_b64_tr_b16 v[98:99], v121 offset:9216
    v_mfma_f32_16x16x32_bf16 v[136:139], v[56:59], v[32:35], v[136:139]
    ds_read_b64_tr_b16 v[100:101], v122 offset:8192
    v_mfma_f32_16x16x32_bf16 v[164:167], v[56:59], v[36:39], v[164:167]
    ds_read_b64_tr_b16 v[102:103], v122 offset:9216
    v_mfma_f32_16x16x32_bf16 v[192:195], v[56:59], v[40:43], v[192:195]
    ds_read_b64_tr_b16 v[104:105], v123 offset:8192
    v_mfma_f32_16x16x32_bf16 v[220:223], v[56:59], v[44:47], v[220:223]
    ds_read_b64_tr_b16 v[106:107], v123 offset:9216
    v_mfma_f32_16x16x32_bf16 v[140:143], v[60:63], v[32:35], v[140:143]
    ds_read_b64_tr_b16 v[108:109], v124 offset:8192
    v_mfma_f32_16x16x32_bf16 v[168:171], v[60:63], v[36:39], v[168:171]
    ds_read_b64_tr_b16 v[110:111], v124 offset:9216
    v_mfma_f32_16x16x32_bf16 v[196:199], v[60:63], v[40:43], v[196:199]
    ds_read_b64_tr_b16 v[112:113], v125 offset:8192
    v_mfma_f32_16x16x32_bf16 v[224:227], v[60:63], v[44:47], v[224:227]
    ds_read_b64_tr_b16 v[114:115], v125 offset:9216
    v_mfma_f32_16x16x32_bf16 v[144:147], v[64:67], v[32:35], v[144:147]
    ds_read_b64_tr_b16 v[116:117], v126 offset:8192
    v_mfma_f32_16x16x32_bf16 v[172:175], v[64:67], v[36:39], v[172:175]
    ds_read_b64_tr_b16 v[118:119], v126 offset:9216
    v_mfma_f32_16x16x32_bf16 v[200:203], v[64:67], v[40:43], v[200:203]
    v_mfma_f32_16x16x32_bf16 v[228:231], v[64:67], v[44:47], v[228:231]
    v_mfma_f32_16x16x32_bf16 v[148:151], v[68:71], v[32:35], v[148:151]
    v_mfma_f32_16x16x32_bf16 v[176:179], v[68:71], v[36:39], v[176:179]
    v_mfma_f32_16x16x32_bf16 v[204:207], v[68:71], v[40:43], v[204:207]
    v_mfma_f32_16x16x32_bf16 v[232:235], v[68:71], v[44:47], v[232:235]
    v_mfma_f32_16x16x32_bf16 v[152:155], v[72:75], v[32:35], v[152:155]
    v_mfma_f32_16x16x32_bf16 v[180:183], v[72:75], v[36:39], v[180:183]
    v_mfma_f32_16x16x32_bf16 v[208:211], v[72:75], v[40:43], v[208:211]
    v_mfma_f32_16x16x32_bf16 v[236:239], v[72:75], v[44:47], v[236:239]
    s_waitcnt vmcnt(0) lgkmcnt(0)
    s_barrier
    v_mfma_f32_16x16x32_bf16 v[128:131], v[92:95], v[76:79], v[128:131]
    v_mfma_f32_16x16x32_bf16 v[156:159], v[92:95], v[80:83], v[156:159]
    v_mfma_f32_16x16x32_bf16 v[184:187], v[92:95], v[84:87], v[184:187]
    v_mfma_f32_16x16x32_bf16 v[212:215], v[92:95], v[88:91], v[212:215]
    v_mfma_f32_16x16x32_bf16 v[132:135], v[96:99], v[76:79], v[132:135]
    v_mfma_f32_16x16x32_bf16 v[160:163], v[96:99], v[80:83], v[160:163]
    v_mfma_f32_16x16x32_bf16 v[188:191], v[96:99], v[84:87], v[188:191]
    v_mfma_f32_16x16x32_bf16 v[216:219], v[96:99], v[88:91], v[216:219]
    v_mfma_f32_16x16x32_bf16 v[136:139], v[100:103], v[76:79], v[136:139]
    v_mfma_f32_16x16x32_bf16 v[164:167], v[100:103], v[80:83], v[164:167]
    v_mfma_f32_16x16x32_bf16 v[192:195], v[100:103], v[84:87], v[192:195]
    v_mfma_f32_16x16x32_bf16 v[220:223], v[100:103], v[88:91], v[220:223]
    v_mfma_f32_16x16x32_bf16 v[140:143], v[104:107], v[76:79], v[140:143]
    v_mfma_f32_16x16x32_bf16 v[168:171], v[104:107], v[80:83], v[168:171]
    v_mfma_f32_16x16x32_bf16 v[196:199], v[104:107], v[84:87], v[196:199]
    v_mfma_f32_16x16x32_bf16 v[224:227], v[104:107], v[88:91], v[224:227]
    v_mfma_f32_16x16x32_bf16 v[144:147], v[108:111], v[76:79], v[144:147]
    v_mfma_f32_16x16x32_bf16 v[172:175], v[108:111], v[80:83], v[172:175]
    v_mfma_f32_16x16x32_bf16 v[200:203], v[108:111], v[84:87], v[200:203]
    v_mfma_f32_16x16x32_bf16 v[228:231], v[108:111], v[88:91], v[228:231]
    v_mfma_f32_16x16x32_bf16 v[148:151], v[112:115], v[76:79], v[148:151]
    v_mfma_f32_16x16x32_bf16 v[176:179], v[112:115], v[80:83], v[176:179]
    v_mfma_f32_16x16x32_bf16 v[204:207], v[112:115], v[84:87], v[204:207]
    v_mfma_f32_16x16x32_bf16 v[232:235], v[112:115], v[88:91], v[232:235]
    v_mfma_f32_16x16x32_bf16 v[152:155], v[116:119], v[76:79], v[152:155]
    v_mfma_f32_16x16x32_bf16 v[180:183], v[116:119], v[80:83], v[180:183]
    v_mfma_f32_16x16x32_bf16 v[208:211], v[116:119], v[84:87], v[208:211]
    v_mfma_f32_16x16x32_bf16 v[236:239], v[116:119], v[88:91], v[236:239]
    s_nop 15
    s_mov_b32 s44, 0xbdd2d3e8
    s_mov_b32 s45, 0xbdd2d3e8
    v_mov_b32 v30, 0xc0135761
    v_mov_b32 v31, 0xc0135761
    s_barrier
    s_lshl_b32 s3, s36, 12
    v_lshlrev_b32 v8, 4, v1
    v_add_u32 v8, s3, v8
    s_cmp_eq_u32 s37, 1
    s_cbranch_scc1 K4_NOEXP
    ds_write_b128 v8, v[152:155] offset:0
    ds_write_b128 v8, v[180:183] offset:1024
    ds_write_b128 v8, v[208:211] offset:2048
    ds_write_b128 v8, v[236:239] offset:3072
    s_waitcnt lgkmcnt(0)
K4_NOEXP:
    s_barrier
    s_cmp_eq_u32 s37, 0
    s_cbranch_scc1 K4_NOIMP
    ds_read_b128 v[32:35], v8 offset:0
    ds_read_b128 v[36:39], v8 offset:1024
    ds_read_b128 v[40:43], v8 offset:2048
    ds_read_b128 v[44:47], v8 offset:3072
K4_NOIMP:
    v_and_b32 v3, 15, v1
    v_lshrrev_b32 v4, 4, v1
    s_lshl_b32 s3, s36, 6
    v_add_u32 v3, s3, v3
    v_mul_u32_u24 v3, 7168, v3
    s_lshl_b32 s3, s37, 7
    v_lshl_add_u32 v3, v4, 3, v3
    v_add_u32 v3, s3, v3
    s_mul_i32 s42, s52, 256*7168
    s_mul_i32 s3, s53, 224
    s_add_u32 s42, s42, s3
    v_cvt_pk_bf16_f32 v64, v128, v129
    v_cvt_pk_bf16_f32 v65, v140, v141
    v_lshlrev_b32 v128, 16, v64
    v_and_b32 v129, 0xffff0000, v64
    v_lshlrev_b32 v140, 16, v65
    v_and_b32 v141, 0xffff0000, v65
    v_pk_mul_f32 v[66:67], v[128:129], v[128:129]
    v_pk_fma_f32 v[66:67], v[66:67], s[44:45], v[30:31]
    v_pk_mul_f32 v[66:67], v[66:67], v[128:129]
    v_exp_f32 v66, v66
    v_exp_f32 v67, v67
    v_cvt_pk_bf16_f32 v64, v130, v131
    v_cvt_pk_bf16_f32 v65, v142, v143
    v_lshlrev_b32 v130, 16, v64
    v_and_b32 v131, 0xffff0000, v64
    v_lshlrev_b32 v142, 16, v65
    v_and_b32 v143, 0xffff0000, v65
    v_pk_mul_f32 v[68:69], v[130:131], v[130:131]
    v_pk_fma_f32 v[68:69], v[68:69], s[44:45], v[30:31]
    v_pk_mul_f32 v[68:69], v[68:69], v[130:131]
    v_exp_f32 v68, v68
    v_exp_f32 v69, v69
    v_pk_add_f32 v[66:67], v[66:67], 1.0 op_sel_hi:[1,0]
    v_rcp_f32 v66, v66
    v_rcp_f32 v67, v67
    v_pk_add_f32 v[68:69], v[68:69], 1.0 op_sel_hi:[1,0]
    v_rcp_f32 v68, v68
    v_rcp_f32 v69, v69
    v_pk_mul_f32 v[128:129], v[128:129], v[66:67]
    v_cvt_pk_bf16_f32 v64, v128, v129
    v_lshlrev_b32 v128, 16, v64
    v_and_b32 v129, 0xffff0000, v64
    v_pk_mul_f32 v[128:129], v[128:129], v[140:141]
    v_cvt_pk_bf16_f32 v72, v128, v129
    v_pk_mul_f32 v[130:131], v[130:131], v[68:69]
    v_cvt_pk_bf16_f32 v64, v130, v131
    v_lshlrev_b32 v130, 16, v64
    v_and_b32 v131, 0xffff0000, v64
    v_pk_mul_f32 v[130:131], v[130:131], v[142:143]
    v_cvt_pk_bf16_f32 v73, v130, v131
    buffer_store_dwordx2 v[72:73], v3, s[20:23], s42 offen offset:0
    v_cvt_pk_bf16_f32 v76, v132, v133
    v_cvt_pk_bf16_f32 v77, v144, v145
    v_lshlrev_b32 v132, 16, v76
    v_and_b32 v133, 0xffff0000, v76
    v_lshlrev_b32 v144, 16, v77
    v_and_b32 v145, 0xffff0000, v77
    v_pk_mul_f32 v[78:79], v[132:133], v[132:133]
    v_pk_fma_f32 v[78:79], v[78:79], s[44:45], v[30:31]
    v_pk_mul_f32 v[78:79], v[78:79], v[132:133]
    v_exp_f32 v78, v78
    v_exp_f32 v79, v79
    v_cvt_pk_bf16_f32 v76, v134, v135
    v_cvt_pk_bf16_f32 v77, v146, v147
    v_lshlrev_b32 v134, 16, v76
    v_and_b32 v135, 0xffff0000, v76
    v_lshlrev_b32 v146, 16, v77
    v_and_b32 v147, 0xffff0000, v77
    v_pk_mul_f32 v[80:81], v[134:135], v[134:135]
    v_pk_fma_f32 v[80:81], v[80:81], s[44:45], v[30:31]
    v_pk_mul_f32 v[80:81], v[80:81], v[134:135]
    v_exp_f32 v80, v80
    v_exp_f32 v81, v81
    v_pk_add_f32 v[78:79], v[78:79], 1.0 op_sel_hi:[1,0]
    v_rcp_f32 v78, v78
    v_rcp_f32 v79, v79
    v_pk_add_f32 v[80:81], v[80:81], 1.0 op_sel_hi:[1,0]
    v_rcp_f32 v80, v80
    v_rcp_f32 v81, v81
    v_pk_mul_f32 v[132:133], v[132:133], v[78:79]
    v_cvt_pk_bf16_f32 v76, v132, v133
    v_lshlrev_b32 v132, 16, v76
    v_and_b32 v133, 0xffff0000, v76
    v_pk_mul_f32 v[132:133], v[132:133], v[144:145]
    v_cvt_pk_bf16_f32 v84, v132, v133
    v_pk_mul_f32 v[134:135], v[134:135], v[80:81]
    v_cvt_pk_bf16_f32 v76, v134, v135
    v_lshlrev_b32 v134, 16, v76
    v_and_b32 v135, 0xffff0000, v76
    v_pk_mul_f32 v[134:135], v[134:135], v[146:147]
    v_cvt_pk_bf16_f32 v85, v134, v135
    buffer_store_dwordx2 v[84:85], v3, s[20:23], s42 offen offset:32
    v_cvt_pk_bf16_f32 v88, v136, v137
    v_cvt_pk_bf16_f32 v89, v148, v149
    v_lshlrev_b32 v136, 16, v88
    v_and_b32 v137, 0xffff0000, v88
    v_lshlrev_b32 v148, 16, v89
    v_and_b32 v149, 0xffff0000, v89
    v_pk_mul_f32 v[90:91], v[136:137], v[136:137]
    v_pk_fma_f32 v[90:91], v[90:91], s[44:45], v[30:31]
    v_pk_mul_f32 v[90:91], v[90:91], v[136:137]
    v_exp_f32 v90, v90
    v_exp_f32 v91, v91
    v_cvt_pk_bf16_f32 v88, v138, v139
    v_cvt_pk_bf16_f32 v89, v150, v151
    v_lshlrev_b32 v138, 16, v88
    v_and_b32 v139, 0xffff0000, v88
    v_lshlrev_b32 v150, 16, v89
    v_and_b32 v151, 0xffff0000, v89
    v_pk_mul_f32 v[92:93], v[138:139], v[138:139]
    v_pk_fma_f32 v[92:93], v[92:93], s[44:45], v[30:31]
    v_pk_mul_f32 v[92:93], v[92:93], v[138:139]
    v_exp_f32 v92, v92
    v_exp_f32 v93, v93
    v_pk_add_f32 v[90:91], v[90:91], 1.0 op_sel_hi:[1,0]
    v_rcp_f32 v90, v90
    v_rcp_f32 v91, v91
    v_pk_add_f32 v[92:93], v[92:93], 1.0 op_sel_hi:[1,0]
    v_rcp_f32 v92, v92
    v_rcp_f32 v93, v93
    v_pk_mul_f32 v[136:137], v[136:137], v[90:91]
    v_cvt_pk_bf16_f32 v88, v136, v137
    v_lshlrev_b32 v136, 16, v88
    v_and_b32 v137, 0xffff0000, v88
    v_pk_mul_f32 v[136:137], v[136:137], v[148:149]
    v_cvt_pk_bf16_f32 v96, v136, v137
    v_pk_mul_f32 v[138:139], v[138:139], v[92:93]
    v_cvt_pk_bf16_f32 v88, v138, v139
    v_lshlrev_b32 v138, 16, v88
    v_and_b32 v139, 0xffff0000, v88
    v_pk_mul_f32 v[138:139], v[138:139], v[150:151]
    v_cvt_pk_bf16_f32 v97, v138, v139
    buffer_store_dwordx2 v[96:97], v3, s[20:23], s42 offen offset:64
    s_add_u32 s42, s42, 114688
    v_cvt_pk_bf16_f32 v100, v156, v157
    v_cvt_pk_bf16_f32 v101, v168, v169
    v_lshlrev_b32 v156, 16, v100
    v_and_b32 v157, 0xffff0000, v100
    v_lshlrev_b32 v168, 16, v101
    v_and_b32 v169, 0xffff0000, v101
    v_pk_mul_f32 v[102:103], v[156:157], v[156:157]
    v_pk_fma_f32 v[102:103], v[102:103], s[44:45], v[30:31]
    v_pk_mul_f32 v[102:103], v[102:103], v[156:157]
    v_exp_f32 v102, v102
    v_exp_f32 v103, v103
    v_cvt_pk_bf16_f32 v100, v158, v159
    v_cvt_pk_bf16_f32 v101, v170, v171
    v_lshlrev_b32 v158, 16, v100
    v_and_b32 v159, 0xffff0000, v100
    v_lshlrev_b32 v170, 16, v101
    v_and_b32 v171, 0xffff0000, v101
    v_pk_mul_f32 v[104:105], v[158:159], v[158:159]
    v_pk_fma_f32 v[104:105], v[104:105], s[44:45], v[30:31]
    v_pk_mul_f32 v[104:105], v[104:105], v[158:159]
    v_exp_f32 v104, v104
    v_exp_f32 v105, v105
    v_pk_add_f32 v[102:103], v[102:103], 1.0 op_sel_hi:[1,0]
    v_rcp_f32 v102, v102
    v_rcp_f32 v103, v103
    v_pk_add_f32 v[104:105], v[104:105], 1.0 op_sel_hi:[1,0]
    v_rcp_f32 v104, v104
    v_rcp_f32 v105, v105
    v_pk_mul_f32 v[156:157], v[156:157], v[102:103]
    v_cvt_pk_bf16_f32 v100, v156, v157
    v_lshlrev_b32 v156, 16, v100
    v_and_b32 v157, 0xffff0000, v100
    v_pk_mul_f32 v[156:157], v[156:157], v[168:169]
    v_cvt_pk_bf16_f32 v108, v156, v157
    v_pk_mul_f32 v[158:159], v[158:159], v[104:105]
    v_cvt_pk_bf16_f32 v100, v158, v159
    v_lshlrev_b32 v158, 16, v100
    v_and_b32 v159, 0xffff0000, v100
    v_pk_mul_f32 v[158:159], v[158:159], v[170:171]
    v_cvt_pk_bf16_f32 v109, v158, v159
    buffer_store_dwordx2 v[108:109], v3, s[20:23], s42 offen offset:0
    v_cvt_pk_bf16_f32 v64, v160, v161
    v_cvt_pk_bf16_f32 v65, v172, v173
    v_lshlrev_b32 v160, 16, v64
    v_and_b32 v161, 0xffff0000, v64
    v_lshlrev_b32 v172, 16, v65
    v_and_b32 v173, 0xffff0000, v65
    v_pk_mul_f32 v[66:67], v[160:161], v[160:161]
    v_pk_fma_f32 v[66:67], v[66:67], s[44:45], v[30:31]
    v_pk_mul_f32 v[66:67], v[66:67], v[160:161]
    v_exp_f32 v66, v66
    v_exp_f32 v67, v67
    v_cvt_pk_bf16_f32 v64, v162, v163
    v_cvt_pk_bf16_f32 v65, v174, v175
    v_lshlrev_b32 v162, 16, v64
    v_and_b32 v163, 0xffff0000, v64
    v_lshlrev_b32 v174, 16, v65
    v_and_b32 v175, 0xffff0000, v65
    v_pk_mul_f32 v[68:69], v[162:163], v[162:163]
    v_pk_fma_f32 v[68:69], v[68:69], s[44:45], v[30:31]
    v_pk_mul_f32 v[68:69], v[68:69], v[162:163]
    v_exp_f32 v68, v68
    v_exp_f32 v69, v69
    v_pk_add_f32 v[66:67], v[66:67], 1.0 op_sel_hi:[1,0]
    v_rcp_f32 v66, v66
    v_rcp_f32 v67, v67
    v_pk_add_f32 v[68:69], v[68:69], 1.0 op_sel_hi:[1,0]
    v_rcp_f32 v68, v68
    v_rcp_f32 v69, v69
    v_pk_mul_f32 v[160:161], v[160:161], v[66:67]
    v_cvt_pk_bf16_f32 v64, v160, v161
    v_lshlrev_b32 v160, 16, v64
    v_and_b32 v161, 0xffff0000, v64
    v_pk_mul_f32 v[160:161], v[160:161], v[172:173]
    v_cvt_pk_bf16_f32 v72, v160, v161
    v_pk_mul_f32 v[162:163], v[162:163], v[68:69]
    v_cvt_pk_bf16_f32 v64, v162, v163
    v_lshlrev_b32 v162, 16, v64
    v_and_b32 v163, 0xffff0000, v64
    v_pk_mul_f32 v[162:163], v[162:163], v[174:175]
    v_cvt_pk_bf16_f32 v73, v162, v163
    buffer_store_dwordx2 v[72:73], v3, s[20:23], s42 offen offset:32
    v_cvt_pk_bf16_f32 v76, v164, v165
    v_cvt_pk_bf16_f32 v77, v176, v177
    v_lshlrev_b32 v164, 16, v76
    v_and_b32 v165, 0xffff0000, v76
    v_lshlrev_b32 v176, 16, v77
    v_and_b32 v177, 0xffff0000, v77
    v_pk_mul_f32 v[78:79], v[164:165], v[164:165]
    v_pk_fma_f32 v[78:79], v[78:79], s[44:45], v[30:31]
    v_pk_mul_f32 v[78:79], v[78:79], v[164:165]
    v_exp_f32 v78, v78
    v_exp_f32 v79, v79
    v_cvt_pk_bf16_f32 v76, v166, v167
    v_cvt_pk_bf16_f32 v77, v178, v179
    v_lshlrev_b32 v166, 16, v76
    v_and_b32 v167, 0xffff0000, v76
    v_lshlrev_b32 v178, 16, v77
    v_and_b32 v179, 0xffff0000, v77
    v_pk_mul_f32 v[80:81], v[166:167], v[166:167]
    v_pk_fma_f32 v[80:81], v[80:81], s[44:45], v[30:31]
    v_pk_mul_f32 v[80:81], v[80:81], v[166:167]
    v_exp_f32 v80, v80
    v_exp_f32 v81, v81
    v_pk_add_f32 v[78:79], v[78:79], 1.0 op_sel_hi:[1,0]
    v_rcp_f32 v78, v78
    v_rcp_f32 v79, v79
    v_pk_add_f32 v[80:81], v[80:81], 1.0 op_sel_hi:[1,0]
    v_rcp_f32 v80, v80
    v_rcp_f32 v81, v81
    v_pk_mul_f32 v[164:165], v[164:165], v[78:79]
    v_cvt_pk_bf16_f32 v76, v164, v165
    v_lshlrev_b32 v164, 16, v76
    v_and_b32 v165, 0xffff0000, v76
    v_pk_mul_f32 v[164:165], v[164:165], v[176:177]
    v_cvt_pk_bf16_f32 v84, v164, v165
    v_pk_mul_f32 v[166:167], v[166:167], v[80:81]
    v_cvt_pk_bf16_f32 v76, v166, v167
    v_lshlrev_b32 v166, 16, v76
    v_and_b32 v167, 0xffff0000, v76
    v_pk_mul_f32 v[166:167], v[166:167], v[178:179]
    v_cvt_pk_bf16_f32 v85, v166, v167
    buffer_store_dwordx2 v[84:85], v3, s[20:23], s42 offen offset:64
    s_add_u32 s42, s42, 114688
    v_cvt_pk_bf16_f32 v88, v184, v185
    v_cvt_pk_bf16_f32 v89, v196, v197
    v_lshlrev_b32 v184, 16, v88
    v_and_b32 v185, 0xffff0000, v88
    v_lshlrev_b32 v196, 16, v89
    v_and_b32 v197, 0xffff0000, v89
    v_pk_mul_f32 v[90:91], v[184:185], v[184:185]
    v_pk_fma_f32 v[90:91], v[90:91], s[44:45], v[30:31]
    v_pk_mul_f32 v[90:91], v[90:91], v[184:185]
    v_exp_f32 v90, v90
    v_exp_f32 v91, v91
    v_cvt_pk_bf16_f32 v88, v186, v187
    v_cvt_pk_bf16_f32 v89, v198, v199
    v_lshlrev_b32 v186, 16, v88
    v_and_b32 v187, 0xffff0000, v88
    v_lshlrev_b32 v198, 16, v89
    v_and_b32 v199, 0xffff0000, v89
    v_pk_mul_f32 v[92:93], v[186:187], v[186:187]
    v_pk_fma_f32 v[92:93], v[92:93], s[44:45], v[30:31]
    v_pk_mul_f32 v[92:93], v[92:93], v[186:187]
    v_exp_f32 v92, v92
    v_exp_f32 v93, v93
    v_pk_add_f32 v[90:91], v[90:91], 1.0 op_sel_hi:[1,0]
    v_rcp_f32 v90, v90
    v_rcp_f32 v91, v91
    v_pk_add_f32 v[92:93], v[92:93], 1.0 op_sel_hi:[1,0]
    v_rcp_f32 v92, v92
    v_rcp_f32 v93, v93
    v_pk_mul_f32 v[184:185], v[184:185], v[90:91]
    v_cvt_pk_bf16_f32 v88, v184, v185
    v_lshlrev_b32 v184, 16, v88
    v_and_b32 v185, 0xffff0000, v88
    v_pk_mul_f32 v[184:185], v[184:185], v[196:197]
    v_cvt_pk_bf16_f32 v96, v184, v185
    v_pk_mul_f32 v[186:187], v[186:187], v[92:93]
    v_cvt_pk_bf16_f32 v88, v186, v187
    v_lshlrev_b32 v186, 16, v88
    v_and_b32 v187, 0xffff0000, v88
    v_pk_mul_f32 v[186:187], v[186:187], v[198:199]
    v_cvt_pk_bf16_f32 v97, v186, v187
    buffer_store_dwordx2 v[96:97], v3, s[20:23], s42 offen offset:0
    v_cvt_pk_bf16_f32 v100, v188, v189
    v_cvt_pk_bf16_f32 v101, v200, v201
    v_lshlrev_b32 v188, 16, v100
    v_and_b32 v189, 0xffff0000, v100
    v_lshlrev_b32 v200, 16, v101
    v_and_b32 v201, 0xffff0000, v101
    v_pk_mul_f32 v[102:103], v[188:189], v[188:189]
    v_pk_fma_f32 v[102:103], v[102:103], s[44:45], v[30:31]
    v_pk_mul_f32 v[102:103], v[102:103], v[188:189]
    v_exp_f32 v102, v102
    v_exp_f32 v103, v103
    v_cvt_pk_bf16_f32 v100, v190, v191
    v_cvt_pk_bf16_f32 v101, v202, v203
    v_lshlrev_b32 v190, 16, v100
    v_and_b32 v191, 0xffff0000, v100
    v_lshlrev_b32 v202, 16, v101
    v_and_b32 v203, 0xffff0000, v101
    v_pk_mul_f32 v[104:105], v[190:191], v[190:191]
    v_pk_fma_f32 v[104:105], v[104:105], s[44:45], v[30:31]
    v_pk_mul_f32 v[104:105], v[104:105], v[190:191]
    v_exp_f32 v104, v104
    v_exp_f32 v105, v105
    v_pk_add_f32 v[102:103], v[102:103], 1.0 op_sel_hi:[1,0]
    v_rcp_f32 v102, v102
    v_rcp_f32 v103, v103
    v_pk_add_f32 v[104:105], v[104:105], 1.0 op_sel_hi:[1,0]
    v_rcp_f32 v104, v104
    v_rcp_f32 v105, v105
    v_pk_mul_f32 v[188:189], v[188:189], v[102:103]
    v_cvt_pk_bf16_f32 v100, v188, v189
    v_lshlrev_b32 v188, 16, v100
    v_and_b32 v189, 0xffff0000, v100
    v_pk_mul_f32 v[188:189], v[188:189], v[200:201]
    v_cvt_pk_bf16_f32 v108, v188, v189
    v_pk_mul_f32 v[190:191], v[190:191], v[104:105]
    v_cvt_pk_bf16_f32 v100, v190, v191
    v_lshlrev_b32 v190, 16, v100
    v_and_b32 v191, 0xffff0000, v100
    v_pk_mul_f32 v[190:191], v[190:191], v[202:203]
    v_cvt_pk_bf16_f32 v109, v190, v191
    buffer_store_dwordx2 v[108:109], v3, s[20:23], s42 offen offset:32
    v_cvt_pk_bf16_f32 v64, v192, v193
    v_cvt_pk_bf16_f32 v65, v204, v205
    v_lshlrev_b32 v192, 16, v64
    v_and_b32 v193, 0xffff0000, v64
    v_lshlrev_b32 v204, 16, v65
    v_and_b32 v205, 0xffff0000, v65
    v_pk_mul_f32 v[66:67], v[192:193], v[192:193]
    v_pk_fma_f32 v[66:67], v[66:67], s[44:45], v[30:31]
    v_pk_mul_f32 v[66:67], v[66:67], v[192:193]
    v_exp_f32 v66, v66
    v_exp_f32 v67, v67
    v_cvt_pk_bf16_f32 v64, v194, v195
    v_cvt_pk_bf16_f32 v65, v206, v207
    v_lshlrev_b32 v194, 16, v64
    v_and_b32 v195, 0xffff0000, v64
    v_lshlrev_b32 v206, 16, v65
    v_and_b32 v207, 0xffff0000, v65
    v_pk_mul_f32 v[68:69], v[194:195], v[194:195]
    v_pk_fma_f32 v[68:69], v[68:69], s[44:45], v[30:31]
    v_pk_mul_f32 v[68:69], v[68:69], v[194:195]
    v_exp_f32 v68, v68
    v_exp_f32 v69, v69
    v_pk_add_f32 v[66:67], v[66:67], 1.0 op_sel_hi:[1,0]
    v_rcp_f32 v66, v66
    v_rcp_f32 v67, v67
    v_pk_add_f32 v[68:69], v[68:69], 1.0 op_sel_hi:[1,0]
    v_rcp_f32 v68, v68
    v_rcp_f32 v69, v69
    v_pk_mul_f32 v[192:193], v[192:193], v[66:67]
    v_cvt_pk_bf16_f32 v64, v192, v193
    v_lshlrev_b32 v192, 16, v64
    v_and_b32 v193, 0xffff0000, v64
    v_pk_mul_f32 v[192:193], v[192:193], v[204:205]
    v_cvt_pk_bf16_f32 v72, v192, v193
    v_pk_mul_f32 v[194:195], v[194:195], v[68:69]
    v_cvt_pk_bf16_f32 v64, v194, v195
    v_lshlrev_b32 v194, 16, v64
    v_and_b32 v195, 0xffff0000, v64
    v_pk_mul_f32 v[194:195], v[194:195], v[206:207]
    v_cvt_pk_bf16_f32 v73, v194, v195
    buffer_store_dwordx2 v[72:73], v3, s[20:23], s42 offen offset:64
    s_add_u32 s42, s42, 114688
    v_cvt_pk_bf16_f32 v76, v212, v213
    v_cvt_pk_bf16_f32 v77, v224, v225
    v_lshlrev_b32 v212, 16, v76
    v_and_b32 v213, 0xffff0000, v76
    v_lshlrev_b32 v224, 16, v77
    v_and_b32 v225, 0xffff0000, v77
    v_pk_mul_f32 v[78:79], v[212:213], v[212:213]
    v_pk_fma_f32 v[78:79], v[78:79], s[44:45], v[30:31]
    v_pk_mul_f32 v[78:79], v[78:79], v[212:213]
    v_exp_f32 v78, v78
    v_exp_f32 v79, v79
    v_cvt_pk_bf16_f32 v76, v214, v215
    v_cvt_pk_bf16_f32 v77, v226, v227
    v_lshlrev_b32 v214, 16, v76
    v_and_b32 v215, 0xffff0000, v76
    v_lshlrev_b32 v226, 16, v77
    v_and_b32 v227, 0xffff0000, v77
    v_pk_mul_f32 v[80:81], v[214:215], v[214:215]
    v_pk_fma_f32 v[80:81], v[80:81], s[44:45], v[30:31]
    v_pk_mul_f32 v[80:81], v[80:81], v[214:215]
    v_exp_f32 v80, v80
    v_exp_f32 v81, v81
    v_pk_add_f32 v[78:79], v[78:79], 1.0 op_sel_hi:[1,0]
    v_rcp_f32 v78, v78
    v_rcp_f32 v79, v79
    v_pk_add_f32 v[80:81], v[80:81], 1.0 op_sel_hi:[1,0]
    v_rcp_f32 v80, v80
    v_rcp_f32 v81, v81
    v_pk_mul_f32 v[212:213], v[212:213], v[78:79]
    v_cvt_pk_bf16_f32 v76, v212, v213
    v_lshlrev_b32 v212, 16, v76
    v_and_b32 v213, 0xffff0000, v76
    v_pk_mul_f32 v[212:213], v[212:213], v[224:225]
    v_cvt_pk_bf16_f32 v84, v212, v213
    v_pk_mul_f32 v[214:215], v[214:215], v[80:81]
    v_cvt_pk_bf16_f32 v76, v214, v215
    v_lshlrev_b32 v214, 16, v76
    v_and_b32 v215, 0xffff0000, v76
    v_pk_mul_f32 v[214:215], v[214:215], v[226:227]
    v_cvt_pk_bf16_f32 v85, v214, v215
    buffer_store_dwordx2 v[84:85], v3, s[20:23], s42 offen offset:0
    v_cvt_pk_bf16_f32 v88, v216, v217
    v_cvt_pk_bf16_f32 v89, v228, v229
    v_lshlrev_b32 v216, 16, v88
    v_and_b32 v217, 0xffff0000, v88
    v_lshlrev_b32 v228, 16, v89
    v_and_b32 v229, 0xffff0000, v89
    v_pk_mul_f32 v[90:91], v[216:217], v[216:217]
    v_pk_fma_f32 v[90:91], v[90:91], s[44:45], v[30:31]
    v_pk_mul_f32 v[90:91], v[90:91], v[216:217]
    v_exp_f32 v90, v90
    v_exp_f32 v91, v91
    v_cvt_pk_bf16_f32 v88, v218, v219
    v_cvt_pk_bf16_f32 v89, v230, v231
    v_lshlrev_b32 v218, 16, v88
    v_and_b32 v219, 0xffff0000, v88
    v_lshlrev_b32 v230, 16, v89
    v_and_b32 v231, 0xffff0000, v89
    v_pk_mul_f32 v[92:93], v[218:219], v[218:219]
    v_pk_fma_f32 v[92:93], v[92:93], s[44:45], v[30:31]
    v_pk_mul_f32 v[92:93], v[92:93], v[218:219]
    v_exp_f32 v92, v92
    v_exp_f32 v93, v93
    v_pk_add_f32 v[90:91], v[90:91], 1.0 op_sel_hi:[1,0]
    v_rcp_f32 v90, v90
    v_rcp_f32 v91, v91
    v_pk_add_f32 v[92:93], v[92:93], 1.0 op_sel_hi:[1,0]
    v_rcp_f32 v92, v92
    v_rcp_f32 v93, v93
    v_pk_mul_f32 v[216:217], v[216:217], v[90:91]
    v_cvt_pk_bf16_f32 v88, v216, v217
    v_lshlrev_b32 v216, 16, v88
    v_and_b32 v217, 0xffff0000, v88
    v_pk_mul_f32 v[216:217], v[216:217], v[228:229]
    v_cvt_pk_bf16_f32 v96, v216, v217
    v_pk_mul_f32 v[218:219], v[218:219], v[92:93]
    v_cvt_pk_bf16_f32 v88, v218, v219
    v_lshlrev_b32 v218, 16, v88
    v_and_b32 v219, 0xffff0000, v88
    v_pk_mul_f32 v[218:219], v[218:219], v[230:231]
    v_cvt_pk_bf16_f32 v97, v218, v219
    buffer_store_dwordx2 v[96:97], v3, s[20:23], s42 offen offset:32
    v_cvt_pk_bf16_f32 v100, v220, v221
    v_cvt_pk_bf16_f32 v101, v232, v233
    v_lshlrev_b32 v220, 16, v100
    v_and_b32 v221, 0xffff0000, v100
    v_lshlrev_b32 v232, 16, v101
    v_and_b32 v233, 0xffff0000, v101
    v_pk_mul_f32 v[102:103], v[220:221], v[220:221]
    v_pk_fma_f32 v[102:103], v[102:103], s[44:45], v[30:31]
    v_pk_mul_f32 v[102:103], v[102:103], v[220:221]
    v_exp_f32 v102, v102
    v_exp_f32 v103, v103
    v_cvt_pk_bf16_f32 v100, v222, v223
    v_cvt_pk_bf16_f32 v101, v234, v235
    v_lshlrev_b32 v222, 16, v100
    v_and_b32 v223, 0xffff0000, v100
    v_lshlrev_b32 v234, 16, v101
    v_and_b32 v235, 0xffff0000, v101
    v_pk_mul_f32 v[104:105], v[222:223], v[222:223]
    v_pk_fma_f32 v[104:105], v[104:105], s[44:45], v[30:31]
    v_pk_mul_f32 v[104:105], v[104:105], v[222:223]
    v_exp_f32 v104, v104
    v_exp_f32 v105, v105
    v_pk_add_f32 v[102:103], v[102:103], 1.0 op_sel_hi:[1,0]
    v_rcp_f32 v102, v102
    v_rcp_f32 v103, v103
    v_pk_add_f32 v[104:105], v[104:105], 1.0 op_sel_hi:[1,0]
    v_rcp_f32 v104, v104
    v_rcp_f32 v105, v105
    v_pk_mul_f32 v[220:221], v[220:221], v[102:103]
    v_cvt_pk_bf16_f32 v100, v220, v221
    v_lshlrev_b32 v220, 16, v100
    v_and_b32 v221, 0xffff0000, v100
    v_pk_mul_f32 v[220:221], v[220:221], v[232:233]
    v_cvt_pk_bf16_f32 v108, v220, v221
    v_pk_mul_f32 v[222:223], v[222:223], v[104:105]
    v_cvt_pk_bf16_f32 v100, v222, v223
    v_lshlrev_b32 v222, 16, v100
    v_and_b32 v223, 0xffff0000, v100
    v_pk_mul_f32 v[222:223], v[222:223], v[234:235]
    v_cvt_pk_bf16_f32 v109, v222, v223
    buffer_store_dwordx2 v[108:109], v3, s[20:23], s42 offen offset:64
    s_add_u32 s42, s42, 114688
    s_cmp_eq_u32 s37, 0
    s_cbranch_scc1 K4_DONE
    s_sub_u32 s42, s42, 458752
    v_add_u32 v3, -32, v3
    s_waitcnt lgkmcnt(0)
    v_cvt_pk_bf16_f32 v64, v32, v33
    v_cvt_pk_bf16_f32 v65, v152, v153
    v_lshlrev_b32 v32, 16, v64
    v_and_b32 v33, 0xffff0000, v64
    v_lshlrev_b32 v152, 16, v65
    v_and_b32 v153, 0xffff0000, v65
    v_pk_mul_f32 v[66:67], v[32:33], v[32:33]
    v_pk_fma_f32 v[66:67], v[66:67], s[44:45], v[30:31]
    v_pk_mul_f32 v[66:67], v[66:67], v[32:33]
    v_exp_f32 v66, v66
    v_exp_f32 v67, v67
    v_cvt_pk_bf16_f32 v64, v34, v35
    v_cvt_pk_bf16_f32 v65, v154, v155
    v_lshlrev_b32 v34, 16, v64
    v_and_b32 v35, 0xffff0000, v64
    v_lshlrev_b32 v154, 16, v65
    v_and_b32 v155, 0xffff0000, v65
    v_pk_mul_f32 v[68:69], v[34:35], v[34:35]
    v_pk_fma_f32 v[68:69], v[68:69], s[44:45], v[30:31]
    v_pk_mul_f32 v[68:69], v[68:69], v[34:35]
    v_exp_f32 v68, v68
    v_exp_f32 v69, v69
    v_pk_add_f32 v[66:67], v[66:67], 1.0 op_sel_hi:[1,0]
    v_rcp_f32 v66, v66
    v_rcp_f32 v67, v67
    v_pk_add_f32 v[68:69], v[68:69], 1.0 op_sel_hi:[1,0]
    v_rcp_f32 v68, v68
    v_rcp_f32 v69, v69
    v_pk_mul_f32 v[32:33], v[32:33], v[66:67]
    v_cvt_pk_bf16_f32 v64, v32, v33
    v_lshlrev_b32 v32, 16, v64
    v_and_b32 v33, 0xffff0000, v64
    v_pk_mul_f32 v[32:33], v[32:33], v[152:153]
    v_cvt_pk_bf16_f32 v72, v32, v33
    v_pk_mul_f32 v[34:35], v[34:35], v[68:69]
    v_cvt_pk_bf16_f32 v64, v34, v35
    v_lshlrev_b32 v34, 16, v64
    v_and_b32 v35, 0xffff0000, v64
    v_pk_mul_f32 v[34:35], v[34:35], v[154:155]
    v_cvt_pk_bf16_f32 v73, v34, v35
    buffer_store_dwordx2 v[72:73], v3, s[20:23], s42 offen
    s_add_u32 s42, s42, 114688
    v_cvt_pk_bf16_f32 v76, v36, v37
    v_cvt_pk_bf16_f32 v77, v180, v181
    v_lshlrev_b32 v36, 16, v76
    v_and_b32 v37, 0xffff0000, v76
    v_lshlrev_b32 v180, 16, v77
    v_and_b32 v181, 0xffff0000, v77
    v_pk_mul_f32 v[78:79], v[36:37], v[36:37]
    v_pk_fma_f32 v[78:79], v[78:79], s[44:45], v[30:31]
    v_pk_mul_f32 v[78:79], v[78:79], v[36:37]
    v_exp_f32 v78, v78
    v_exp_f32 v79, v79
    v_cvt_pk_bf16_f32 v76, v38, v39
    v_cvt_pk_bf16_f32 v77, v182, v183
    v_lshlrev_b32 v38, 16, v76
    v_and_b32 v39, 0xffff0000, v76
    v_lshlrev_b32 v182, 16, v77
    v_and_b32 v183, 0xffff0000, v77
    v_pk_mul_f32 v[80:81], v[38:39], v[38:39]
    v_pk_fma_f32 v[80:81], v[80:81], s[44:45], v[30:31]
    v_pk_mul_f32 v[80:81], v[80:81], v[38:39]
    v_exp_f32 v80, v80
    v_exp_f32 v81, v81
    v_pk_add_f32 v[78:79], v[78:79], 1.0 op_sel_hi:[1,0]
    v_rcp_f32 v78, v78
    v_rcp_f32 v79, v79
    v_pk_add_f32 v[80:81], v[80:81], 1.0 op_sel_hi:[1,0]
    v_rcp_f32 v80, v80
    v_rcp_f32 v81, v81
    v_pk_mul_f32 v[36:37], v[36:37], v[78:79]
    v_cvt_pk_bf16_f32 v76, v36, v37
    v_lshlrev_b32 v36, 16, v76
    v_and_b32 v37, 0xffff0000, v76
    v_pk_mul_f32 v[36:37], v[36:37], v[180:181]
    v_cvt_pk_bf16_f32 v84, v36, v37
    v_pk_mul_f32 v[38:39], v[38:39], v[80:81]
    v_cvt_pk_bf16_f32 v76, v38, v39
    v_lshlrev_b32 v38, 16, v76
    v_and_b32 v39, 0xffff0000, v76
    v_pk_mul_f32 v[38:39], v[38:39], v[182:183]
    v_cvt_pk_bf16_f32 v85, v38, v39
    buffer_store_dwordx2 v[84:85], v3, s[20:23], s42 offen
    s_add_u32 s42, s42, 114688
    v_cvt_pk_bf16_f32 v88, v40, v41
    v_cvt_pk_bf16_f32 v89, v208, v209
    v_lshlrev_b32 v40, 16, v88
    v_and_b32 v41, 0xffff0000, v88
    v_lshlrev_b32 v208, 16, v89
    v_and_b32 v209, 0xffff0000, v89
    v_pk_mul_f32 v[90:91], v[40:41], v[40:41]
    v_pk_fma_f32 v[90:91], v[90:91], s[44:45], v[30:31]
    v_pk_mul_f32 v[90:91], v[90:91], v[40:41]
    v_exp_f32 v90, v90
    v_exp_f32 v91, v91
    v_cvt_pk_bf16_f32 v88, v42, v43
    v_cvt_pk_bf16_f32 v89, v210, v211
    v_lshlrev_b32 v42, 16, v88
    v_and_b32 v43, 0xffff0000, v88
    v_lshlrev_b32 v210, 16, v89
    v_and_b32 v211, 0xffff0000, v89
    v_pk_mul_f32 v[92:93], v[42:43], v[42:43]
    v_pk_fma_f32 v[92:93], v[92:93], s[44:45], v[30:31]
    v_pk_mul_f32 v[92:93], v[92:93], v[42:43]
    v_exp_f32 v92, v92
    v_exp_f32 v93, v93
    v_pk_add_f32 v[90:91], v[90:91], 1.0 op_sel_hi:[1,0]
    v_rcp_f32 v90, v90
    v_rcp_f32 v91, v91
    v_pk_add_f32 v[92:93], v[92:93], 1.0 op_sel_hi:[1,0]
    v_rcp_f32 v92, v92
    v_rcp_f32 v93, v93
    v_pk_mul_f32 v[40:41], v[40:41], v[90:91]
    v_cvt_pk_bf16_f32 v88, v40, v41
    v_lshlrev_b32 v40, 16, v88
    v_and_b32 v41, 0xffff0000, v88
    v_pk_mul_f32 v[40:41], v[40:41], v[208:209]
    v_cvt_pk_bf16_f32 v96, v40, v41
    v_pk_mul_f32 v[42:43], v[42:43], v[92:93]
    v_cvt_pk_bf16_f32 v88, v42, v43
    v_lshlrev_b32 v42, 16, v88
    v_and_b32 v43, 0xffff0000, v88
    v_pk_mul_f32 v[42:43], v[42:43], v[210:211]
    v_cvt_pk_bf16_f32 v97, v42, v43
    buffer_store_dwordx2 v[96:97], v3, s[20:23], s42 offen
    s_add_u32 s42, s42, 114688
    v_cvt_pk_bf16_f32 v100, v44, v45
    v_cvt_pk_bf16_f32 v101, v236, v237
    v_lshlrev_b32 v44, 16, v100
    v_and_b32 v45, 0xffff0000, v100
    v_lshlrev_b32 v236, 16, v101
    v_and_b32 v237, 0xffff0000, v101
    v_pk_mul_f32 v[102:103], v[44:45], v[44:45]
    v_pk_fma_f32 v[102:103], v[102:103], s[44:45], v[30:31]
    v_pk_mul_f32 v[102:103], v[102:103], v[44:45]
    v_exp_f32 v102, v102
    v_exp_f32 v103, v103
    v_cvt_pk_bf16_f32 v100, v46, v47
    v_cvt_pk_bf16_f32 v101, v238, v239
    v_lshlrev_b32 v46, 16, v100
    v_and_b32 v47, 0xffff0000, v100
    v_lshlrev_b32 v238, 16, v101
    v_and_b32 v239, 0xffff0000, v101
    v_pk_mul_f32 v[104:105], v[46:47], v[46:47]
    v_pk_fma_f32 v[104:105], v[104:105], s[44:45], v[30:31]
    v_pk_mul_f32 v[104:105], v[104:105], v[46:47]
    v_exp_f32 v104, v104
    v_exp_f32 v105, v105
    v_pk_add_f32 v[102:103], v[102:103], 1.0 op_sel_hi:[1,0]
    v_rcp_f32 v102, v102
    v_rcp_f32 v103, v103
    v_pk_add_f32 v[104:105], v[104:105], 1.0 op_sel_hi:[1,0]
    v_rcp_f32 v104, v104
    v_rcp_f32 v105, v105
    v_pk_mul_f32 v[44:45], v[44:45], v[102:103]
    v_cvt_pk_bf16_f32 v100, v44, v45
    v_lshlrev_b32 v44, 16, v100
    v_and_b32 v45, 0xffff0000, v100
    v_pk_mul_f32 v[44:45], v[44:45], v[236:237]
    v_cvt_pk_bf16_f32 v108, v44, v45
    v_pk_mul_f32 v[46:47], v[46:47], v[104:105]
    v_cvt_pk_bf16_f32 v100, v46, v47
    v_lshlrev_b32 v46, 16, v100
    v_and_b32 v47, 0xffff0000, v100
    v_pk_mul_f32 v[46:47], v[46:47], v[238:239]
    v_cvt_pk_bf16_f32 v109, v46, v47
    buffer_store_dwordx2 v[108:109], v3, s[20:23], s42 offen
    s_add_u32 s42, s42, 114688
K4_DONE:
K4_END:
    s_endpgm
.globl k5_kernel
.p2align 8
.type k5_kernel,@function
k5_kernel:
    s_cmp_ge_u32 s2, 256
    s_cbranch_scc1 K5_END
    s_load_dwordx4 s[4:7], s[0:1], 48
    s_load_dwordx4 s[28:31], s[0:1], 64
    v_and_b32 v1, 63, v0
    v_lshrrev_b32 v2, 6, v0
    s_nop 0
    v_readfirstlane_b32 s27, v2
    s_and_b32 s3, s2, 7
    s_lshr_b32 s34, s2, 3
    s_lshr_b32 s54, s3, 1
    s_and_b32 s54, s54, 1
    s_lshl_b32 s54, s54, 3
    s_and_b32 s35, s34, 7
    s_add_u32 s52, s54, s35
    s_lshr_b32 s35, s3, 2
    s_lshl_b32 s35, s35, 2
    s_lshr_b32 s34, s34, 3
    s_add_u32 s53, s35, s34
    s_lshr_b32 s36, s27, 1
    s_and_b32 s37, s27, 1
    s_lshl_b32 s39, s52, 3
    s_add_u32 s39, s39, s53
    s_lshr_b32 s40, s39, 1
    s_lshl_b32 s40, s40, 2
    s_and_b32 s41, s39, 1
    s_lshl_b32 s41, s41, 4
    s_lshl_b32 s42, 1, s41
    s_lshl_b32 s43, 0x100, s41
    s_waitcnt lgkmcnt(0)
    s_mov_b32 s44, s28
    s_and_b32 s45, s29, 0xffff
    s_mov_b32 s46, 0x100
    s_mov_b32 s47, 0x00020000
    s_cmp_lg_u32 s27, 0
    s_cbranch_scc1 K5_TK
    v_mov_b32 v6, s42
    v_mov_b32 v7, s40
    s_mov_b64 exec, 1
    buffer_atomic_add v6, v7, s[44:47], 0 offen sc0 sc1
    s_mov_b64 exec, -1
K5_TK:
    s_add_u32 s8, s30, 0x2000000
    s_addc_u32 s9, s31, 0x0
    s_and_b32 s9, s9, 0xffff
    s_mov_b32 s10, 0xe00000
    s_mov_b32 s11, 0x00020000
    s_mov_b32 s12, s4
    s_and_b32 s13, s5, 0xffff
    s_mov_b32 s14, 0x700000
    s_mov_b32 s15, 0x00020000
    s_mov_b32 s16, s6
    s_and_b32 s17, s7, 0xffff
    s_mov_b32 s18, 0x400000
    s_mov_b32 s19, 0x00020000
    s_add_u32 s20, s30, 0x3000000
    s_addc_u32 s21, s31, 0x0
    s_and_b32 s21, s21, 0xffff
    s_mov_b32 s22, 0x800000
    s_mov_b32 s23, 0x00020000
    s_lshl_b32 s30, s27, 12
    s_add_u32 s31, s30, 16384
    v_lshrrev_b32 v3, 3, v1
    v_and_b32 v4, 7, v1
    v_xor_b32 v4, v4, v3
    v_lshlrev_b32 v4, 4, v4
    v_mul_u32_u24 v3, 7168, v3
    v_add_u32 v10, v3, v4
    v_lshrrev_b32 v3, 4, v1
    v_and_b32 v4, 15, v1
    v_or_b32 v5, 0, v3
    v_lshlrev_b32 v5, 1, v5
    v_xor_b32 v5, v5, v4
    v_lshlrev_b32 v5, 4, v5
    v_lshl_add_u32 v11, v3, 11, v5
    v_or_b32 v5, 4, v3
    v_lshlrev_b32 v5, 1, v5
    v_xor_b32 v5, v5, v4
    v_lshlrev_b32 v5, 4, v5
    v_lshl_add_u32 v12, v3, 11, v5
    v_and_b32 v3, 15, v1
    v_lshrrev_b32 v4, 4, v1
    v_and_b32 v5, 7, v1
    s_lshl_b32 s3, s36, 13
    v_add_u32 v8, 0, v4
    v_xor_b32 v8, v8, v5
    v_lshlrev_b32 v8, 4, v8
    v_lshl_add_u32 v8, v3, 7, v8
    v_add_u32 v14, s3, v8
    v_add_u32 v16, 65536, v14
    v_add_u32 v8, 4, v4
    v_xor_b32 v8, v8, v5
    v_lshlrev_b32 v8, 4, v8
    v_lshl_add_u32 v8, v3, 7, v8
    v_add_u32 v15, s3, v8
    v_add_u32 v17, 65536, v15
    v_lshrrev_b32 v5, 2, v3
    v_lshl_add_u32 v8, v4, 3, v5
    v_lshlrev_b32 v8, 8, v8
    v_and_b32 v9, 3, v1
    v_lshl_add_u32 v8, v9, 3, v8
    v_add_u32 v8, 16384, v8
    v_and_b32 v9, 1, v4
    v_lshl_or_b32 v5, v9, 2, v5
    s_lshl_b32 s3, s37, 2
    s_add_u32 s4, s3, 0
    v_xor_b32 v9, s4, v5
    v_lshl_add_u32 v18, v9, 5, v8
    v_add_u32 v22, 65536, v18
    s_add_u32 s4, s3, 1
    v_xor_b32 v9, s4, v5
    v_lshl_add_u32 v19, v9, 5, v8
    v_add_u32 v23, 65536, v19
    s_add_u32 s4, s3, 2
    v_xor_b32 v9, s4, v5
    v_lshl_add_u32 v20, v9, 5, v8
    v_add_u32 v24, 65536, v20
    s_add_u32 s4, s3, 3
    v_xor_b32 v9, s4, v5
    v_lshl_add_u32 v21, v9, 5, v8
    v_add_u32 v25, 65536, v21
    s_lshl_b32 s3, s36, 6
    v_add_u32 v3, s3, v3
    v_lshlrev_b32 v3, 11, v3
    s_lshl_b32 s3, s37, 7
    v_lshl_add_u32 v3, v4, 3, v3
    v_add_u32 v26, s3, v3
    v_lshlrev_b32 v27, 4, v1
    s_and_b32 s56, s2, 1
    s_mov_b32 s55, 0
    s_mov_b32 s26, 5
    s_mul_i32 s35, s56, 3520
    s_mov_b32 s57, 128
    s_mov_b32 s58, 131072
    s_cmp_eq_u32 s56, 1
    s_cselect_b32 s57, -128, s57
    s_cselect_b32 s58, -131072, s58
    s_lshl_b32 s24, s52, 7
    s_lshl_b32 s3, s27, 5
    s_add_u32 s24, s24, s3
    s_mul_i32 s24, s24, 7168
    s_lshl_b32 s3, s35, 1
    s_add_u32 s24, s24, s3
    s_lshl_b32 s3, s27, 4
    s_add_u32 s25, s35, s3
    s_lshl_b32 s25, s25, 11
    s_lshl_b32 s3, s53, 8
    s_add_u32 s25, s25, s3
    v_mov_b32 v28, 0x20000
    s_add_u32 m0, s30, 0
    s_add_u32 s33, s24, 0
    buffer_load_dwordx4 v10, s[8:11], s33 offen lds
    s_add_u32 m0, s30, 1024
    s_add_u32 s33, s24, 57344
    buffer_load_dwordx4 v10, s[8:11], s33 offen lds
    s_add_u32 m0, s30, 2048
    s_add_u32 s33, s24, 114688
    buffer_load_dwordx4 v10, s[8:11], s33 offen lds
    s_add_u32 m0, s30, 3072
    s_add_u32 s33, s24, 172032
    buffer_load_dwordx4 v10, s[8:11], s33 offen lds
    s_add_u32 m0, s31, 0
    s_add_u32 s33, s25, 0
    buffer_load_dwordx4 v11, s[12:15], s33 offen lds
    s_add_u32 m0, s31, 1024
    s_add_u32 s33, s25, 8192
    buffer_load_dwordx4 v11, s[12:15], s33 offen lds
    s_add_u32 m0, s31, 2048
    s_add_u32 s33, s25, 16384
    buffer_load_dwordx4 v12, s[12:15], s33 offen lds
    s_add_u32 m0, s31, 3072
    s_add_u32 s33, s25, 24576
    buffer_load_dwordx4 v12, s[12:15], s33 offen lds
    s_add_u32 s24, s24, s57
    s_add_u32 s25, s25, s58
    s_add_u32 m0, s30, 32768
    s_add_u32 s33, s24, 0
    buffer_load_dwordx4 v10, s[8:11], s33 offen lds
    s_add_u32 m0, s30, 33792
    s_add_u32 s33, s24, 57344
    buffer_load_dwordx4 v10, s[8:11], s33 offen lds
    s_add_u32 m0, s30, 34816
    s_add_u32 s33, s24, 114688
    buffer_load_dwordx4 v10, s[8:11], s33 offen lds
    s_add_u32 m0, s30, 35840
    s_add_u32 s33, s24, 172032
    buffer_load_dwordx4 v10, s[8:11], s33 offen lds
    s_add_u32 m0, s31, 32768
    s_add_u32 s33, s25, 0
    buffer_load_dwordx4 v11, s[12:15], s33 offen lds
    s_add_u32 m0, s31, 33792
    s_add_u32 s33, s25, 8192
    buffer_load_dwordx4 v11, s[12:15], s33 offen lds
    s_add_u32 m0, s31, 34816
    s_add_u32 s33, s25, 16384
    buffer_load_dwordx4 v12, s[12:15], s33 offen lds
    s_add_u32 m0, s31, 35840
    s_add_u32 s33, s25, 24576
    buffer_load_dwordx4 v12, s[12:15], s33 offen lds
    s_add_u32 s24, s24, s57
    s_add_u32 s25, s25, s58
    s_add_u32 m0, s30, 65536
    s_add_u32 s33, s24, 0
    buffer_load_dwordx4 v10, s[8:11], s33 offen lds
    s_add_u32 m0, s30, 66560
    s_add_u32 s33, s24, 57344
    buffer_load_dwordx4 v10, s[8:11], s33 offen lds
    s_add_u32 m0, s30, 67584
    s_add_u32 s33, s24, 114688
    buffer_load_dwordx4 v10, s[8:11], s33 offen lds
    s_add_u32 m0, s30, 68608
    s_add_u32 s33, s24, 172032
    buffer_load_dwordx4 v10, s[8:11], s33 offen lds
    s_add_u32 m0, s31, 65536
    s_add_u32 s33, s25, 0
    buffer_load_dwordx4 v11, s[12:15], s33 offen lds
    s_add_u32 m0, s31, 66560
    s_add_u32 s33, s25, 8192
    buffer_load_dwordx4 v11, s[12:15], s33 offen lds
    s_add_u32 m0, s31, 67584
    s_add_u32 s33, s25, 16384
    buffer_load_dwordx4 v12, s[12:15], s33 offen lds
    s_add_u32 m0, s31, 68608
    s_add_u32 s33, s25, 24576
    buffer_load_dwordx4 v12, s[12:15], s33 offen lds
    s_add_u32 s24, s24, s57
    s_add_u32 s25, s25, s58
    v_mov_b32 v128, 0
    v_mov_b32 v129, 0
    v_mov_b32 v130, 0
    v_mov_b32 v131, 0
    v_mov_b32 v132, 0
    v_mov_b32 v133, 0
    v_mov_b32 v134, 0
    v_mov_b32 v135, 0
    v_mov_b32 v136, 0
    v_mov_b32 v137, 0
    v_mov_b32 v138, 0
    v_mov_b32 v139, 0
    v_mov_b32 v140, 0
    v_mov_b32 v141, 0
    v_mov_b32 v142, 0
    v_mov_b32 v143, 0
    v_mov_b32 v144, 0
    v_mov_b32 v145, 0
    v_mov_b32 v146, 0
    v_mov_b32 v147, 0
    v_mov_b32 v148, 0
    v_mov_b32 v149, 0
    v_mov_b32 v150, 0
    v_mov_b32 v151, 0
    v_mov_b32 v152, 0
    v_mov_b32 v153, 0
    v_mov_b32 v154, 0
    v_mov_b32 v155, 0
    v_mov_b32 v156, 0
    v_mov_b32 v157, 0
    v_mov_b32 v158, 0
    v_mov_b32 v159, 0
    v_mov_b32 v160, 0
    v_mov_b32 v161, 0
    v_mov_b32 v162, 0
    v_mov_b32 v163, 0
    v_mov_b32 v164, 0
    v_mov_b32 v165, 0
    v_mov_b32 v166, 0
    v_mov_b32 v167, 0
    v_mov_b32 v168, 0
    v_mov_b32 v169, 0
    v_mov_b32 v170, 0
    v_mov_b32 v171, 0
    v_mov_b32 v172, 0
    v_mov_b32 v173, 0
    v_mov_b32 v174, 0
    v_mov_b32 v175, 0
    v_mov_b32 v176, 0
    v_mov_b32 v177, 0
    v_mov_b32 v178, 0
    v_mov_b32 v179, 0
    v_mov_b32 v180, 0
    v_mov_b32 v181, 0
    v_mov_b32 v182, 0
    v_mov_b32 v183, 0
    v_mov_b32 v184, 0
    v_mov_b32 v185, 0
    v_mov_b32 v186, 0
    v_mov_b32 v187, 0
    v_mov_b32 v188, 0
    v_mov_b32 v189, 0
    v_mov_b32 v190, 0
    v_mov_b32 v191, 0
    s_waitcnt vmcnt(16)
    s_barrier
    ds_read_b128 v[32:35], v14 offset:0
    ds_read_b128 v[36:39], v14 offset:2048
    ds_read_b128 v[40:43], v14 offset:4096
    ds_read_b128 v[44:47], v14 offset:6144
    ds_read_b64_tr_b16 v[48:49], v18 offset:0
    ds_read_b64_tr_b16 v[50:51], v18 offset:1024
    ds_read_b64_tr_b16 v[52:53], v19 offset:0
    ds_read_b64_tr_b16 v[54:55], v19 offset:1024
    ds_read_b64_tr_b16 v[56:57], v20 offset:0
    ds_read_b64_tr_b16 v[58:59], v20 offset:1024
    ds_read_b64_tr_b16 v[60:61], v21 offset:0
    ds_read_b64_tr_b16 v[62:63], v21 offset:1024
K5_LOOP:
    s_waitcnt lgkmcnt(0)
    v_mfma_f32_16x16x32_bf16 v[128:131], v[48:51], v[32:35], v[128:131]
    ds_read_b128 v[64:67], v15 offset:0
    v_mfma_f32_16x16x32_bf16 v[144:147], v[48:51], v[36:39], v[144:147]
    ds_read_b128 v[68:71], v15 offset:2048
    v_mfma_f32_16x16x32_bf16 v[160:163], v[48:51], v[40:43], v[160:163]
    ds_read_b128 v[72:75], v15 offset:4096
    v_mfma_f32_16x16x32_bf16 v[176:179], v[48:51], v[44:47], v[176:179]
    ds_read_b128 v[76:79], v15 offset:6144
    v_mfma_f32_16x16x32_bf16 v[132:135], v[52:55], v[32:35], v[132:135]
    ds_read_b64_tr_b16 v[80:81], v18 offset:8192
    v_mfma_f32_16x16x32_bf16 v[148:151], v[52:55], v[36:39], v[148:151]
    ds_read_b64_tr_b16 v[82:83], v18 offset:9216
    v_mfma_f32_16x16x32_bf16 v[164:167], v[52:55], v[40:43], v[164:167]
    ds_read_b64_tr_b16 v[84:85], v19 offset:8192
    v_mfma_f32_16x16x32_bf16 v[180:183], v[52:55], v[44:47], v[180:183]
    ds_read_b64_tr_b16 v[86:87], v19 offset:9216
    v_mfma_f32_16x16x32_bf16 v[136:139], v[56:59], v[32:35], v[136:139]
    ds_read_b64_tr_b16 v[88:89], v20 offset:8192
    v_mfma_f32_16x16x32_bf16 v[152:155], v[56:59], v[36:39], v[152:155]
    ds_read_b64_tr_b16 v[90:91], v20 offset:9216
    v_mfma_f32_16x16x32_bf16 v[168:171], v[56:59], v[40:43], v[168:171]
    ds_read_b64_tr_b16 v[92:93], v21 offset:8192
    v_mfma_f32_16x16x32_bf16 v[184:187], v[56:59], v[44:47], v[184:187]
    ds_read_b64_tr_b16 v[94:95], v21 offset:9216
    v_mfma_f32_16x16x32_bf16 v[140:143], v[60:63], v[32:35], v[140:143]
    v_mfma_f32_16x16x32_bf16 v[156:159], v[60:63], v[36:39], v[156:159]
    v_mfma_f32_16x16x32_bf16 v[172:175], v[60:63], v[40:43], v[172:175]
    v_mfma_f32_16x16x32_bf16 v[188:191], v[60:63], v[44:47], v[188:191]
    s_waitcnt vmcnt(8) lgkmcnt(0)
    s_barrier
    v_mfma_f32_16x16x32_bf16 v[128:131], v[80:83], v[64:67], v[128:131]
    ds_read_b128 v[32:35], v14 offset:32768
    v_mfma_f32_16x16x32_bf16 v[144:147], v[80:83], v[68:71], v[144:147]
    s_add_u32 m0, s30, 98304
    s_add_u32 s33, s24, 0
    buffer_load_dwordx4 v10, s[8:11], s33 offen lds
    v_mfma_f32_16x16x32_bf16 v[160:163], v[80:83], v[72:75], v[160:163]
    ds_read_b128 v[36:39], v14 offset:34816
    v_mfma_f32_16x16x32_bf16 v[176:179], v[80:83], v[76:79], v[176:179]
    s_add_u32 m0, s30, 99328
    s_add_u32 s33, s24, 57344
    buffer_load_dwordx4 v10, s[8:11], s33 offen lds
    v_mfma_f32_16x16x32_bf16 v[132:135], v[84:87], v[64:67], v[132:135]
    ds_read_b128 v[40:43], v14 offset:36864
    v_mfma_f32_16x16x32_bf16 v[148:151], v[84:87], v[68:71], v[148:151]
    s_add_u32 m0, s30, 100352
    s_add_u32 s33, s24, 114688
    buffer_load_dwordx4 v10, s[8:11], s33 offen lds
    v_mfma_f32_16x16x32_bf16 v[164:167], v[84:87], v[72:75], v[164:167]
    ds_read_b128 v[44:47], v14 offset:38912
    v_mfma_f32_16x16x32_bf16 v[180:183], v[84:87], v[76:79], v[180:183]
    s_add_u32 m0, s30, 101376
    s_add_u32 s33, s24, 172032
    buffer_load_dwordx4 v10, s[8:11], s33 offen lds
    v_mfma_f32_16x16x32_bf16 v[136:139], v[88:91], v[64:67], v[136:139]
    ds_read_b64_tr_b16 v[48:49], v18 offset:32768
    v_mfma_f32_16x16x32_bf16 v[152:155], v[88:91], v[68:71], v[152:155]
    s_add_u32 m0, s31, 98304
    s_add_u32 s33, s25, 0
    buffer_load_dwordx4 v11, s[12:15], s33 offen lds
    v_mfma_f32_16x16x32_bf16 v[168:171], v[88:91], v[72:75], v[168:171]
    ds_read_b64_tr_b16 v[50:51], v18 offset:33792
    v_mfma_f32_16x16x32_bf16 v[184:187], v[88:91], v[76:79], v[184:187]
    s_add_u32 m0, s31, 99328
    s_add_u32 s33, s25, 8192
    buffer_load_dwordx4 v11, s[12:15], s33 offen lds
    v_mfma_f32_16x16x32_bf16 v[140:143], v[92:95], v[64:67], v[140:143]
    ds_read_b64_tr_b16 v[52:53], v19 offset:32768
    v_mfma_f32_16x16x32_bf16 v[156:159], v[92:95], v[68:71], v[156:159]
    s_add_u32 m0, s31, 100352
    s_add_u32 s33, s25, 16384
    buffer_load_dwordx4 v12, s[12:15], s33 offen lds
    v_mfma_f32_16x16x32_bf16 v[172:175], v[92:95], v[72:75], v[172:175]
    ds_read_b64_tr_b16 v[54:55], v19 offset:33792
    v_mfma_f32_16x16x32_bf16 v[188:191], v[92:95], v[76:79], v[188:191]
    s_add_u32 m0, s31, 101376
    s_add_u32 s33, s25, 24576
    buffer_load_dwordx4 v12, s[12:15], s33 offen lds
    ds_read_b64_tr_b16 v[56:57], v20 offset:32768
    ds_read_b64_tr_b16 v[58:59], v20 offset:33792
    ds_read_b64_tr_b16 v[60:61], v21 offset:32768
    ds_read_b64_tr_b16 v[62:63], v21 offset:33792
    s_add_u32 s24, s24, s57
    s_add_u32 s25, s25, s58
    s_waitcnt lgkmcnt(0)
    v_mfma_f32_16x16x32_bf16 v[128:131], v[48:51], v[32:35], v[128:131]
    ds_read_b128 v[64:67], v15 offset:32768
    v_mfma_f32_16x16x32_bf16 v[144:147], v[48:51], v[36:39], v[144:147]
    ds_read_b128 v[68:71], v15 offset:34816
    v_mfma_f32_16x16x32_bf16 v[160:163], v[48:51], v[40:43], v[160:163]
    ds_read_b128 v[72:75], v15 offset:36864
    v_mfma_f32_16x16x32_bf16 v[176:179], v[48:51], v[44:47], v[176:179]
    ds_read_b128 v[76:79], v15 offset:38912
    v_mfma_f32_16x16x32_bf16 v[132:135], v[52:55], v[32:35], v[132:135]
    ds_read_b64_tr_b16 v[80:81], v18 offset:40960
    v_mfma_f32_16x16x32_bf16 v[148:151], v[52:55], v[36:39], v[148:151]
    ds_read_b64_tr_b16 v[82:83], v18 offset:41984
    v_mfma_f32_16x16x32_bf16 v[164:167], v[52:55], v[40:43], v[164:167]
    ds_read_b64_tr_b16 v[84:85], v19 offset:40960
    v_mfma_f32_16x16x32_bf16 v[180:183], v[52:55], v[44:47], v[180:183]
    ds_read_b64_tr_b16 v[86:87], v19 offset:41984
    v_mfma_f32_16x16x32_bf16 v[136:139], v[56:59], v[32:35], v[136:139]
    ds_read_b64_tr_b16 v[88:89], v20 offset:40960
    v_mfma_f32_16x16x32_bf16 v[152:155], v[56:59], v[36:39], v[152:155]
    ds_read_b64_tr_b16 v[90:91], v20 offset:41984
    v_mfma_f32_16x16x32_bf16 v[168:171], v[56:59], v[40:43], v[168:171]
    ds_read_b64_tr_b16 v[92:93], v21 offset:40960
    v_mfma_f32_16x16x32_bf16 v[184:187], v[56:59], v[44:47], v[184:187]
    ds_read_b64_tr_b16 v[94:95], v21 offset:41984
    v_mfma_f32_16x16x32_bf16 v[140:143], v[60:63], v[32:35], v[140:143]
    v_mfma_f32_16x16x32_bf16 v[156:159], v[60:63], v[36:39], v[156:159]
    v_mfma_f32_16x16x32_bf16 v[172:175], v[60:63], v[40:43], v[172:175]
    v_mfma_f32_16x16x32_bf16 v[188:191], v[60:63], v[44:47], v[188:191]
    s_waitcnt vmcnt(8) lgkmcnt(0)
    s_barrier
    v_mfma_f32_16x16x32_bf16 v[128:131], v[80:83], v[64:67], v[128:131]
    ds_read_b128 v[32:35], v16 offset:0
    v_mfma_f32_16x16x32_bf16 v[144:147], v[80:83], v[68:71], v[144:147]
    s_add_u32 m0, s30, 0
    s_add_u32 s33, s24, 0
    buffer_load_dwordx4 v10, s[8:11], s33 offen lds
    v_mfma_f32_16x16x32_bf16 v[160:163], v[80:83], v[72:75], v[160:163]
    ds_read_b128 v[36:39], v16 offset:2048
    v_mfma_f32_16x16x32_bf16 v[176:179], v[80:83], v[76:79], v[176:179]
    s_add_u32 m0, s30, 1024
    s_add_u32 s33, s24, 57344
    buffer_load_dwordx4 v10, s[8:11], s33 offen lds
    v_mfma_f32_16x16x32_bf16 v[132:135], v[84:87], v[64:67], v[132:135]
    ds_read_b128 v[40:43], v16 offset:4096
    v_mfma_f32_16x16x32_bf16 v[148:151], v[84:87], v[68:71], v[148:151]
    s_add_u32 m0, s30, 2048
    s_add_u32 s33, s24, 114688
    buffer_load_dwordx4 v10, s[8:11], s33 offen lds
    v_mfma_f32_16x16x32_bf16 v[164:167], v[84:87], v[72:75], v[164:167]
    ds_read_b128 v[44:47], v16 offset:6144
    v_mfma_f32_16x16x32_bf16 v[180:183], v[84:87], v[76:79], v[180:183]
    s_add_u32 m0, s30, 3072
    s_add_u32 s33, s24, 172032
    buffer_load_dwordx4 v10, s[8:11], s33 offen lds
    v_mfma_f32_16x16x32_bf16 v[136:139], v[88:91], v[64:67], v[136:139]
    ds_read_b64_tr_b16 v[48:49], v22 offset:0
    v_mfma_f32_16x16x32_bf16 v[152:155], v[88:91], v[68:71], v[152:155]
    s_add_u32 m0, s31, 0
    s_add_u32 s33, s25, 0
    buffer_load_dwordx4 v11, s[12:15], s33 offen lds
    v_mfma_f32_16x16x32_bf16 v[168:171], v[88:91], v[72:75], v[168:171]
    ds_read_b64_tr_b16 v[50:51], v22 offset:1024
    v_mfma_f32_16x16x32_bf16 v[184:187], v[88:91], v[76:79], v[184:187]
    s_add_u32 m0, s31, 1024
    s_add_u32 s33, s25, 8192
    buffer_load_dwordx4 v11, s[12:15], s33 offen lds
    v_mfma_f32_16x16x32_bf16 v[140:143], v[92:95], v[64:67], v[140:143]
    ds_read_b64_tr_b16 v[52:53], v23 offset:0
    v_mfma_f32_16x16x32_bf16 v[156:159], v[92:95], v[68:71], v[156:159]
    s_add_u32 m0, s31, 2048
    s_add_u32 s33, s25, 16384
    buffer_load_dwordx4 v12, s[12:15], s33 offen lds
    v_mfma_f32_16x16x32_bf16 v[172:175], v[92:95], v[72:75], v[172:175]
    ds_read_b64_tr_b16 v[54:55], v23 offset:1024
    v_mfma_f32_16x16x32_bf16 v[188:191], v[92:95], v[76:79], v[188:191]
    s_add_u32 m0, s31, 3072
    s_add_u32 s33, s25, 24576
    buffer_load_dwordx4 v12, s[12:15], s33 offen lds
    ds_read_b64_tr_b16 v[56:57], v24 offset:0
    ds_read_b64_tr_b16 v[58:59], v24 offset:1024
    ds_read_b64_tr_b16 v[60:61], v25 offset:0
    ds_read_b64_tr_b16 v[62:63], v25 offset:1024
    s_add_u32 s24, s24, s57
    s_add_u32 s25, s25, s58
    s_waitcnt lgkmcnt(0)
    v_mfma_f32_16x16x32_bf16 v[128:131], v[48:51], v[32:35], v[128:131]
    ds_read_b128 v[64:67], v17 offset:0
    v_mfma_f32_16x16x32_bf16 v[144:147], v[48:51], v[36:39], v[144:147]
    ds_read_b128 v[68:71], v17 offset:2048
    v_mfma_f32_16x16x32_bf16 v[160:163], v[48:51], v[40:43], v[160:163]
    ds_read_b128 v[72:75], v17 offset:4096
    v_mfma_f32_16x16x32_bf16 v[176:179], v[48:51], v[44:47], v[176:179]
    ds_read_b128 v[76:79], v17 offset:6144
    v_mfma_f32_16x16x32_bf16 v[132:135], v[52:55], v[32:35], v[132:135]
    ds_read_b64_tr_b16 v[80:81], v22 offset:8192
    v_mfma_f32_16x16x32_bf16 v[148:151], v[52:55], v[36:39], v[148:151]
    ds_read_b64_tr_b16 v[82:83], v22 offset:9216
    v_mfma_f32_16x16x32_bf16 v[164:167], v[52:55], v[40:43], v[164:167]
    ds_read_b64_tr_b16 v[84:85], v23 offset:8192
    v_mfma_f32_16x16x32_bf16 v[180:183], v[52:55], v[44:47], v[180:183]
    ds_read_b64_tr_b16 v[86:87], v23 offset:9216
    v_mfma_f32_16x16x32_bf16 v[136:139], v[56:59], v[32:35], v[136:139]
    ds_read_b64_tr_b16 v[88:89], v24 offset:8192
    v_mfma_f32_16x16x32_bf16 v[152:155], v[56:59], v[36:39], v[152:155]
    ds_read_b64_tr_b16 v[90:91], v24 offset:9216
    v_mfma_f32_16x16x32_bf16 v[168:171], v[56:59], v[40:43], v[168:171]
    ds_read_b64_tr_b16 v[92:93], v25 offset:8192
    v_mfma_f32_16x16x32_bf16 v[184:187], v[56:59], v[44:47], v[184:187]
    ds_read_b64_tr_b16 v[94:95], v25 offset:9216
    v_mfma_f32_16x16x32_bf16 v[140:143], v[60:63], v[32:35], v[140:143]
    v_mfma_f32_16x16x32_bf16 v[156:159], v[60:63], v[36:39], v[156:159]
    v_mfma_f32_16x16x32_bf16 v[172:175], v[60:63], v[40:43], v[172:175]
    v_mfma_f32_16x16x32_bf16 v[188:191], v[60:63], v[44:47], v[188:191]
    s_waitcnt vmcnt(8) lgkmcnt(0)
    s_barrier
    v_mfma_f32_16x16x32_bf16 v[128:131], v[80:83], v[64:67], v[128:131]
    ds_read_b128 v[32:35], v16 offset:32768
    v_mfma_f32_16x16x32_bf16 v[144:147], v[80:83], v[68:71], v[144:147]
    s_add_u32 m0, s30, 32768
    s_add_u32 s33, s24, 0
    buffer_load_dwordx4 v10, s[8:11], s33 offen lds
    v_mfma_f32_16x16x32_bf16 v[160:163], v[80:83], v[72:75], v[160:163]
    ds_read_b128 v[36:39], v16 offset:34816
    v_mfma_f32_16x16x32_bf16 v[176:179], v[80:83], v[76:79], v[176:179]
    s_add_u32 m0, s30, 33792
    s_add_u32 s33, s24, 57344
    buffer_load_dwordx4 v10, s[8:11], s33 offen lds
    v_mfma_f32_16x16x32_bf16 v[132:135], v[84:87], v[64:67], v[132:135]
    ds_read_b128 v[40:43], v16 offset:36864
    v_mfma_f32_16x16x32_bf16 v[148:151], v[84:87], v[68:71], v[148:151]
    s_add_u32 m0, s30, 34816
    s_add_u32 s33, s24, 114688
    buffer_load_dwordx4 v10, s[8:11], s33 offen lds
    v_mfma_f32_16x16x32_bf16 v[164:167], v[84:87], v[72:75], v[164:167]
    ds_read_b128 v[44:47], v16 offset:38912
    v_mfma_f32_16x16x32_bf16 v[180:183], v[84:87], v[76:79], v[180:183]
    s_add_u32 m0, s30, 35840
    s_add_u32 s33, s24, 172032
    buffer_load_dwordx4 v10, s[8:11], s33 offen lds
    v_mfma_f32_16x16x32_bf16 v[136:139], v[88:91], v[64:67], v[136:139]
    ds_read_b64_tr_b16 v[48:49], v22 offset:32768
    v_mfma_f32_16x16x32_bf16 v[152:155], v[88:91], v[68:71], v[152:155]
    s_add_u32 m0, s31, 32768
    s_add_u32 s33, s25, 0
    buffer_load_dwordx4 v11, s[12:15], s33 offen lds
    v_mfma_f32_16x16x32_bf16 v[168:171], v[88:91], v[72:75], v[168:171]
    ds_read_b64_tr_b16 v[50:51], v22 offset:33792
    v_mfma_f32_16x16x32_bf16 v[184:187], v[88:91], v[76:79], v[184:187]
    s_add_u32 m0, s31, 33792
    s_add_u32 s33, s25, 8192
    buffer_load_dwordx4 v11, s[12:15], s33 offen lds
    v_mfma_f32_16x16x32_bf16 v[140:143], v[92:95], v[64:67], v[140:143]
    ds_read_b64_tr_b16 v[52:53], v23 offset:32768
    v_mfma_f32_16x16x32_bf16 v[156:159], v[92:95], v[68:71], v[156:159]
    s_add_u32 m0, s31, 34816
    s_add_u32 s33, s25, 16384
    buffer_load_dwordx4 v12, s[12:15], s33 offen lds
    v_mfma_f32_16x16x32_bf16 v[172:175], v[92:95], v[72:75], v[172:175]
    ds_read_b64_tr_b16 v[54:55], v23 offset:33792
    v_mfma_f32_16x16x32_bf16 v[188:191], v[92:95], v[76:79], v[188:191]
    s_add_u32 m0, s31, 35840
    s_add_u32 s33, s25, 24576
    buffer_load_dwordx4 v12, s[12:15], s33 offen lds
    ds_read_b64_tr_b16 v[56:57], v24 offset:32768
    ds_read_b64_tr_b16 v[58:59], v24 offset:33792
    ds_read_b64_tr_b16 v[60:61], v25 offset:32768
    ds_read_b64_tr_b16 v[62:63], v25 offset:33792
    s_add_u32 s24, s24, s57
    s_add_u32 s25, s25, s58
    s_waitcnt lgkmcnt(0)
    v_mfma_f32_16x16x32_bf16 v[128:131], v[48:51], v[32:35], v[128:131]
    ds_read_b128 v[64:67], v17 offset:32768
    v_mfma_f32_16x16x32_bf16 v[144:147], v[48:51], v[36:39], v[144:147]
    ds_read_b128 v[68:71], v17 offset:34816
    v_mfma_f32_16x16x32_bf16 v[160:163], v[48:51], v[40:43], v[160:163]
    ds_read_b128 v[72:75], v17 offset:36864
    v_mfma_f32_16x16x32_bf16 v[176:179], v[48:51], v[44:47], v[176:179]
    ds_read_b128 v[76:79], v17 offset:38912
    v_mfma_f32_16x16x32_bf16 v[132:135], v[52:55], v[32:35], v[132:135]
    ds_read_b64_tr_b16 v[80:81], v22 offset:40960
    v_mfma_f32_16x16x32_bf16 v[148:151], v[52:55], v[36:39], v[148:151]
    ds_read_b64_tr_b16 v[82:83], v22 offset:41984
    v_mfma_f32_16x16x32_bf16 v[164:167], v[52:55], v[40:43], v[164:167]
    ds_read_b64_tr_b16 v[84:85], v23 offset:40960
    v_mfma_f32_16x16x32_bf16 v[180:183], v[52:55], v[44:47], v[180:183]
    ds_read_b64_tr_b16 v[86:87], v23 offset:41984
    v_mfma_f32_16x16x32_bf16 v[136:139], v[56:59], v[32:35], v[136:139]
    ds_read_b64_tr_b16 v[88:89], v24 offset:40960
    v_mfma_f32_16x16x32_bf16 v[152:155], v[56:59], v[36:39], v[152:155]
    ds_read_b64_tr_b16 v[90:91], v24 offset:41984
    v_mfma_f32_16x16x32_bf16 v[168:171], v[56:59], v[40:43], v[168:171]
    ds_read_b64_tr_b16 v[92:93], v25 offset:40960
    v_mfma_f32_16x16x32_bf16 v[184:187], v[56:59], v[44:47], v[184:187]
    ds_read_b64_tr_b16 v[94:95], v25 offset:41984
    v_mfma_f32_16x16x32_bf16 v[140:143], v[60:63], v[32:35], v[140:143]
    v_mfma_f32_16x16x32_bf16 v[156:159], v[60:63], v[36:39], v[156:159]
    v_mfma_f32_16x16x32_bf16 v[172:175], v[60:63], v[40:43], v[172:175]
    v_mfma_f32_16x16x32_bf16 v[188:191], v[60:63], v[44:47], v[188:191]
    s_waitcnt vmcnt(8) lgkmcnt(0)
    s_barrier
    v_mfma_f32_16x16x32_bf16 v[128:131], v[80:83], v[64:67], v[128:131]
    ds_read_b128 v[32:35], v14 offset:0
    v_mfma_f32_16x16x32_bf16 v[144:147], v[80:83], v[68:71], v[144:147]
    s_add_u32 m0, s30, 65536
    s_add_u32 s33, s24, 0
    buffer_load_dwordx4 v10, s[8:11], s33 offen lds
    v_mfma_f32_16x16x32_bf16 v[160:163], v[80:83], v[72:75], v[160:163]
    ds_read_b128 v[36:39], v14 offset:2048
    v_mfma_f32_16x16x32_bf16 v[176:179], v[80:83], v[76:79], v[176:179]
    s_add_u32 m0, s30, 66560
    s_add_u32 s33, s24, 57344
    buffer_load_dwordx4 v10, s[8:11], s33 offen lds
    v_mfma_f32_16x16x32_bf16 v[132:135], v[84:87], v[64:67], v[132:135]
    ds_read_b128 v[40:43], v14 offset:4096
    v_mfma_f32_16x16x32_bf16 v[148:151], v[84:87], v[68:71], v[148:151]
    s_add_u32 m0, s30, 67584
    s_add_u32 s33, s24, 114688
    buffer_load_dwordx4 v10, s[8:11], s33 offen lds
    v_mfma_f32_16x16x32_bf16 v[164:167], v[84:87], v[72:75], v[164:167]
    ds_read_b128 v[44:47], v14 offset:6144
    v_mfma_f32_16x16x32_bf16 v[180:183], v[84:87], v[76:79], v[180:183]
    s_add_u32 m0, s30, 68608
    s_add_u32 s33, s24, 172032
    buffer_load_dwordx4 v10, s[8:11], s33 offen lds
    v_mfma_f32_16x16x32_bf16 v[136:139], v[88:91], v[64:67], v[136:139]
    ds_read_b64_tr_b16 v[48:49], v18 offset:0
    v_mfma_f32_16x16x32_bf16 v[152:155], v[88:91], v[68:71], v[152:155]
    s_add_u32 m0, s31, 65536
    s_add_u32 s33, s25, 0
    buffer_load_dwordx4 v11, s[12:15], s33 offen lds
    v_mfma_f32_16x16x32_bf16 v[168:171], v[88:91], v[72:75], v[168:171]
    ds_read_b64_tr_b16 v[50:51], v18 offset:1024
    v_mfma_f32_16x16x32_bf16 v[184:187], v[88:91], v[76:79], v[184:187]
    s_add_u32 m0, s31, 66560
    s_add_u32 s33, s25, 8192
    buffer_load_dwordx4 v11, s[12:15], s33 offen lds
    v_mfma_f32_16x16x32_bf16 v[140:143], v[92:95], v[64:67], v[140:143]
    ds_read_b64_tr_b16 v[52:53], v19 offset:0
    v_mfma_f32_16x16x32_bf16 v[156:159], v[92:95], v[68:71], v[156:159]
    s_add_u32 m0, s31, 67584
    s_add_u32 s33, s25, 16384
    buffer_load_dwordx4 v12, s[12:15], s33 offen lds
    v_mfma_f32_16x16x32_bf16 v[172:175], v[92:95], v[72:75], v[172:175]
    ds_read_b64_tr_b16 v[54:55], v19 offset:1024
    v_mfma_f32_16x16x32_bf16 v[188:191], v[92:95], v[76:79], v[188:191]
    s_add_u32 m0, s31, 68608
    s_add_u32 s33, s25, 24576
    buffer_load_dwordx4 v12, s[12:15], s33 offen lds
    ds_read_b64_tr_b16 v[56:57], v20 offset:0
    ds_read_b64_tr_b16 v[58:59], v20 offset:1024
    ds_read_b64_tr_b16 v[60:61], v21 offset:0
    ds_read_b64_tr_b16 v[62:63], v21 offset:1024
    s_add_u32 s24, s24, s57
    s_add_u32 s25, s25, s58
    s_cmp_lg_u32 s27, 0
    s_cbranch_scc1 K5_NOTK
    s_mov_b64 exec, 1
    ds_write_b32 v28, v6
    s_mov_b64 exec, -1
K5_NOTK:
    s_sub_u32 s26, s26, 1
    s_cmp_lg_u32 s26, 0
    s_cbranch_scc1 K5_LOOP
    s_cmp_lg_u32 s55, 0
    s_cbranch_scc1 K5_TAIL
    s_mov_b32 s55, 1
    ds_read_b32 v29, v28
    s_waitcnt lgkmcnt(0)
    s_nop 0
    v_readfirstlane_b32 s38, v29
    s_nop 3
    s_lshr_b32 s38, s38, s41
    s_and_b32 s38, s38, 1
    s_mov_b32 s26, 2
    s_cmp_eq_u32 s38, 1
    s_cbranch_scc1 K5_LOOP
K5_TAIL:
    s_mov_b32 s59, 0
    s_waitcnt lgkmcnt(0)
    v_mfma_f32_16x16x32_bf16 v[128:131], v[48:51], v[32:35], v[128:131]
    ds_read_b128 v[64:67], v15 offset:0
    v_mfma_f32_16x16x32_bf16 v[144:147], v[48:51], v[36:39], v[144:147]
    ds_read_b128 v[68:71], v15 offset:2048
    v_mfma_f32_16x16x32_bf16 v[160:163], v[48:51], v[40:43], v[160:163]
    ds_read_b128 v[72:75], v15 offset:4096
    v_mfma_f32_16x16x32_bf16 v[176:179], v[48:51], v[44:47], v[176:179]
    ds_read_b128 v[76:79], v15 offset:6144
    v_mfma_f32_16x16x32_bf16 v[132:135], v[52:55], v[32:35], v[132:135]
    ds_read_b64_tr_b16 v[80:81], v18 offset:8192
    v_mfma_f32_16x16x32_bf16 v[148:151], v[52:55], v[36:39], v[148:151]
    ds_read_b64_tr_b16 v[82:83], v18 offset:9216
    v_mfma_f32_16x16x32_bf16 v[164:167], v[52:55], v[40:43], v[164:167]
    ds_read_b64_tr_b16 v[84:85], v19 offset:8192
    v_mfma_f32_16x16x32_bf16 v[180:183], v[52:55], v[44:47], v[180:183]
    ds_read_b64_tr_b16 v[86:87], v19 offset:9216
    v_mfma_f32_16x16x32_bf16 v[136:139], v[56:59], v[32:35], v[136:139]
    ds_read_b64_tr_b16 v[88:89], v20 offset:8192
    v_mfma_f32_16x16x32_bf16 v[152:155], v[56:59], v[36:39], v[152:155]
    ds_read_b64_tr_b16 v[90:91], v20 offset:9216
    v_mfma_f32_16x16x32_bf16 v[168:171], v[56:59], v[40:43], v[168:171]
    ds_read_b64_tr_b16 v[92:93], v21 offset:8192
    v_mfma_f32_16x16x32_bf16 v[184:187], v[56:59], v[44:47], v[184:187]
    ds_read_b64_tr_b16 v[94:95], v21 offset:9216
    v_mfma_f32_16x16x32_bf16 v[140:143], v[60:63], v[32:35], v[140:143]
    v_mfma_f32_16x16x32_bf16 v[156:159], v[60:63], v[36:39], v[156:159]
    v_mfma_f32_16x16x32_bf16 v[172:175], v[60:63], v[40:43], v[172:175]
    v_mfma_f32_16x16x32_bf16 v[188:191], v[60:63], v[44:47], v[188:191]
    s_waitcnt vmcnt(8) lgkmcnt(0)
    s_barrier
    v_mfma_f32_16x16x32_bf16 v[128:131], v[80:83], v[64:67], v[128:131]
    ds_read_b128 v[32:35], v14 offset:32768
    v_mfma_f32_16x16x32_bf16 v[144:147], v[80:83], v[68:71], v[144:147]
    s_add_u32 m0, s30, 98304
    s_add_u32 s33, s24, 0
    buffer_load_dwordx4 v10, s[8:11], s33 offen lds
    v_mfma_f32_16x16x32_bf16 v[160:163], v[80:83], v[72:75], v[160:163]
    ds_read_b128 v[36:39], v14 offset:34816
    v_mfma_f32_16x16x32_bf16 v[176:179], v[80:83], v[76:79], v[176:179]
    s_add_u32 m0, s30, 99328
    s_add_u32 s33, s24, 57344
    buffer_load_dwordx4 v10, s[8:11], s33 offen lds
    v_mfma_f32_16x16x32_bf16 v[132:135], v[84:87], v[64:67], v[132:135]
    ds_read_b128 v[40:43], v14 offset:36864
    v_mfma_f32_16x16x32_bf16 v[148:151], v[84:87], v[68:71], v[148:151]
    s_add_u32 m0, s30, 100352
    s_add_u32 s33, s24, 114688
    buffer_load_dwordx4 v10, s[8:11], s33 offen lds
    v_mfma_f32_16x16x32_bf16 v[164:167], v[84:87], v[72:75], v[164:167]
    ds_read_b128 v[44:47], v14 offset:38912
    v_mfma_f32_16x16x32_bf16 v[180:183], v[84:87], v[76:79], v[180:183]
    s_add_u32 m0, s30, 101376
    s_add_u32 s33, s24, 172032
    buffer_load_dwordx4 v10, s[8:11], s33 offen lds
    v_mfma_f32_16x16x32_bf16 v[136:139], v[88:91], v[64:67], v[136:139]
    ds_read_b64_tr_b16 v[48:49], v18 offset:32768
    v_mfma_f32_16x16x32_bf16 v[152:155], v[88:91], v[68:71], v[152:155]
    s_add_u32 m0, s31, 98304
    s_add_u32 s33, s25, 0
    buffer_load_dwordx4 v11, s[12:15], s33 offen lds
    v_mfma_f32_16x16x32_bf16 v[168:171], v[88:91], v[72:75], v[168:171]
    ds_read_b64_tr_b16 v[50:51], v18 offset:33792
    v_mfma_f32_16x16x32_bf16 v[184:187], v[88:91], v[76:79], v[184:187]
    s_add_u32 m0, s31, 99328
    s_add_u32 s33, s25, 8192
    buffer_load_dwordx4 v11, s[12:15], s33 offen lds
    v_mfma_f32_16x16x32_bf16 v[140:143], v[92:95], v[64:67], v[140:143]
    ds_read_b64_tr_b16 v[52:53], v19 offset:32768
    v_mfma_f32_16x16x32_bf16 v[156:159], v[92:95], v[68:71], v[156:159]
    s_add_u32 m0, s31, 100352
    s_add_u32 s33, s25, 16384
    buffer_load_dwordx4 v12, s[12:15], s33 offen lds
    v_mfma_f32_16x16x32_bf16 v[172:175], v[92:95], v[72:75], v[172:175]
    ds_read_b64_tr_b16 v[54:55], v19 offset:33792
    v_mfma_f32_16x16x32_bf16 v[188:191], v[92:95], v[76:79], v[188:191]
    s_add_u32 m0, s31, 101376
    s_add_u32 s33, s25, 24576
    buffer_load_dwordx4 v12, s[12:15], s33 offen lds
    ds_read_b64_tr_b16 v[56:57], v20 offset:32768
    ds_read_b64_tr_b16 v[58:59], v20 offset:33792
    ds_read_b64_tr_b16 v[60:61], v21 offset:32768
    ds_read_b64_tr_b16 v[62:63], v21 offset:33792
    s_add_u32 s24, s24, s57
    s_add_u32 s25, s25, s58
    v_mov_b32 v7, s40
    buffer_load_dword v29, v7, s[44:47], 0 offen sc1
    s_waitcnt lgkmcnt(0)
    v_mfma_f32_16x16x32_bf16 v[128:131], v[48:51], v[32:35], v[128:131]
    ds_read_b128 v[64:67], v15 offset:32768
    v_mfma_f32_16x16x32_bf16 v[144:147], v[48:51], v[36:39], v[144:147]
    ds_read_b128 v[68:71], v15 offset:34816
    v_mfma_f32_16x16x32_bf16 v[160:163], v[48:51], v[40:43], v[160:163]
    ds_read_b128 v[72:75], v15 offset:36864
    v_mfma_f32_16x16x32_bf16 v[176:179], v[48:51], v[44:47], v[176:179]
    ds_read_b128 v[76:79], v15 offset:38912
    v_mfma_f32_16x16x32_bf16 v[132:135], v[52:55], v[32:35], v[132:135]
    ds_read_b64_tr_b16 v[80:81], v18 offset:40960
    v_mfma_f32_16x16x32_bf16 v[148:151], v[52:55], v[36:39], v[148:151]
    ds_read_b64_tr_b16 v[82:83], v18 offset:41984
    v_mfma_f32_16x16x32_bf16 v[164:167], v[52:55], v[40:43], v[164:167]
    ds_read_b64_tr_b16 v[84:85], v19 offset:40960
    v_mfma_f32_16x16x32_bf16 v[180:183], v[52:55], v[44:47], v[180:183]
    ds_read_b64_tr_b16 v[86:87], v19 offset:41984
    v_mfma_f32_16x16x32_bf16 v[136:139], v[56:59], v[32:35], v[136:139]
    ds_read_b64_tr_b16 v[88:89], v20 offset:40960
    v_mfma_f32_16x16x32_bf16 v[152:155], v[56:59], v[36:39], v[152:155]
    ds_read_b64_tr_b16 v[90:91], v20 offset:41984
    v_mfma_f32_16x16x32_bf16 v[168:171], v[56:59], v[40:43], v[168:171]
    ds_read_b64_tr_b16 v[92:93], v21 offset:40960
    v_mfma_f32_16x16x32_bf16 v[184:187], v[56:59], v[44:47], v[184:187]
    ds_read_b64_tr_b16 v[94:95], v21 offset:41984
    v_mfma_f32_16x16x32_bf16 v[140:143], v[60:63], v[32:35], v[140:143]
    v_mfma_f32_16x16x32_bf16 v[156:159], v[60:63], v[36:39], v[156:159]
    v_mfma_f32_16x16x32_bf16 v[172:175], v[60:63], v[40:43], v[172:175]
    v_mfma_f32_16x16x32_bf16 v[188:191], v[60:63], v[44:47], v[188:191]
    s_waitcnt vmcnt(9) lgkmcnt(0)
    s_barrier
    v_mfma_f32_16x16x32_bf16 v[128:131], v[80:83], v[64:67], v[128:131]
    ds_read_b128 v[32:35], v16 offset:0
    v_mfma_f32_16x16x32_bf16 v[144:147], v[80:83], v[68:71], v[144:147]
    ds_read_b128 v[36:39], v16 offset:2048
    v_mfma_f32_16x16x32_bf16 v[160:163], v[80:83], v[72:75], v[160:163]
    ds_read_b128 v[40:43], v16 offset:4096
    v_mfma_f32_16x16x32_bf16 v[176:179], v[80:83], v[76:79], v[176:179]
    ds_read_b128 v[44:47], v16 offset:6144
    v_mfma_f32_16x16x32_bf16 v[132:135], v[84:87], v[64:67], v[132:135]
    ds_read_b64_tr_b16 v[48:49], v22 offset:0
    v_mfma_f32_16x16x32_bf16 v[148:151], v[84:87], v[68:71], v[148:151]
    ds_read_b64_tr_b16 v[50:51], v22 offset:1024
    v_mfma_f32_16x16x32_bf16 v[164:167], v[84:87], v[72:75], v[164:167]
    ds_read_b64_tr_b16 v[52:53], v23 offset:0
    v_mfma_f32_16x16x32_bf16 v[180:183], v[84:87], v[76:79], v[180:183]
    ds_read_b64_tr_b16 v[54:55], v23 offset:1024
    v_mfma_f32_16x16x32_bf16 v[136:139], v[88:91], v[64:67], v[136:139]
    ds_read_b64_tr_b16 v[56:57], v24 offset:0
    v_mfma_f32_16x16x32_bf16 v[152:155], v[88:91], v[68:71], v[152:155]
    ds_read_b64_tr_b16 v[58:59], v24 offset:1024
    v_mfma_f32_16x16x32_bf16 v[168:171], v[88:91], v[72:75], v[168:171]
    ds_read_b64_tr_b16 v[60:61], v25 offset:0
    v_mfma_f32_16x16x32_bf16 v[184:187], v[88:91], v[76:79], v[184:187]
    ds_read_b64_tr_b16 v[62:63], v25 offset:1024
    v_mfma_f32_16x16x32_bf16 v[140:143], v[92:95], v[64:67], v[140:143]
    v_mfma_f32_16x16x32_bf16 v[156:159], v[92:95], v[68:71], v[156:159]
    v_mfma_f32_16x16x32_bf16 v[172:175], v[92:95], v[72:75], v[172:175]
    v_mfma_f32_16x16x32_bf16 v[188:191], v[92:95], v[76:79], v[188:191]
    s_cmp_eq_u32 s38, 0
    s_cbranch_scc1 K5_NOPRE
    s_waitcnt vmcnt(0)
    v_readfirstlane_b32 s35, v29
    s_nop 3
    s_and_b32 s35, s35, s43
    s_cmp_eq_u32 s35, 0
    s_cbranch_scc1 K5_NOPRE
    s_mov_b32 s59, 1
    s_lshl_b32 s34, s39, 16
    s_lshl_b32 s3, s27, 14
    s_add_u32 s34, s34, s3
    s_add_u32 s33, s34, 0
    buffer_load_dwordx4 v[192:195], v27, s[20:23], s33 offen sc1
    s_add_u32 s33, s34, 1024
    buffer_load_dwordx4 v[196:199], v27, s[20:23], s33 offen sc1
    s_add_u32 s33, s34, 2048
    buffer_load_dwordx4 v[200:203], v27, s[20:23], s33 offen sc1
    s_add_u32 s33, s34, 3072
    buffer_load_dwordx4 v[204:207], v27, s[20:23], s33 offen sc1
    s_add_u32 s33, s34, 4096
    buffer_load_dwordx4 v[208:211], v27, s[20:23], s33 offen sc1
    s_add_u32 s33, s34, 5120
    buffer_load_dwordx4 v[212:215], v27, s[20:23], s33 offen sc1
    s_add_u32 s33, s34, 6144
    buffer_load_dwordx4 v[216:219], v27, s[20:23], s33 offen sc1
    s_add_u32 s33, s34, 7168
    buffer_load_dwordx4 v[220:223], v27, s[20:23], s33 offen sc1
    s_add_u32 s33, s34, 8192
    buffer_load_dwordx4 v[224:227], v27, s[20:23], s33 offen sc1
    s_add_u32 s33, s34, 9216
    buffer_load_dwordx4 v[228:231], v27, s[20:23], s33 offen sc1
    s_add_u32 s33, s34, 10240
    buffer_load_dwordx4 v[232:235], v27, s[20:23], s33 offen sc1
    s_add_u32 s33, s34, 11264
    buffer_load_dwordx4 v[236:239], v27, s[20:23], s33 offen sc1
    s_add_u32 s33, s34, 12288
    buffer_load_dwordx4 v[240:243], v27, s[20:23], s33 offen sc1
    s_add_u32 s33, s34, 13312
    buffer_load_dwordx4 v[244:247], v27, s[20:23], s33 offen sc1
    s_add_u32 s33, s34, 14336
    buffer_load_dwordx4 v[248:251], v27, s[20:23], s33 offen sc1
    s_add_u32 s33, s34, 15360
    buffer_load_dwordx4 v[252:255], v27, s[20:23], s33 offen sc1
    s_lshl_b32 s42, s52, 18
    s_lshl_b32 s3, s53, 8
    s_add_u32 s42, s42, s3
    s_add_u32 s48, s42, 0
    s_add_u32 s49, s42, 32768
    s_add_u32 s50, s42, 65536
    s_add_u32 s51, s42, 98304
    buffer_load_dwordx2 v[96:97], v26, s[16:19], s48 offen offset:0
    buffer_load_dwordx2 v[98:99], v26, s[16:19], s48 offen offset:32
    buffer_load_dwordx2 v[100:101], v26, s[16:19], s48 offen offset:64
    buffer_load_dwordx2 v[102:103], v26, s[16:19], s48 offen offset:96
    buffer_load_dwordx2 v[104:105], v26, s[16:19], s49 offen offset:0
    buffer_load_dwordx2 v[106:107], v26, s[16:19], s49 offen offset:32
    buffer_load_dwordx2 v[108:109], v26, s[16:19], s49 offen offset:64
    buffer_load_dwordx2 v[110:111], v26, s[16:19], s49 offen offset:96
    buffer_load_dwordx2 v[112:113], v26, s[16:19], s50 offen offset:0
    buffer_load_dwordx2 v[114:115], v26, s[16:19], s50 offen offset:32
    buffer_load_dwordx2 v[116:117], v26, s[16:19], s50 offen offset:64
    buffer_load_dwordx2 v[118:119], v26, s[16:19], s50 offen offset:96
    buffer_load_dwordx2 v[120:121], v26, s[16:19], s51 offen offset:0
    buffer_load_dwordx2 v[122:123], v26, s[16:19], s51 offen offset:32
    buffer_load_dwordx2 v[124:125], v26, s[16:19], s51 offen offset:64
    buffer_load_dwordx2 v[126:127], v26, s[16:19], s51 offen offset:96
    s_waitcnt lgkmcnt(0)
    v_mfma_f32_16x16x32_bf16 v[128:131], v[48:51], v[32:35], v[128:131]
    ds_read_b128 v[64:67], v17 offset:0
    v_mfma_f32_16x16x32_bf16 v[144:147], v[48:51], v[36:39], v[144:147]
    ds_read_b128 v[68:71], v17 offset:2048
    v_mfma_f32_16x16x32_bf16 v[160:163], v[48:51], v[40:43], v[160:163]
    ds_read_b128 v[72:75], v17 offset:4096
    v_mfma_f32_16x16x32_bf16 v[176:179], v[48:51], v[44:47], v[176:179]
    ds_read_b128 v[76:79], v17 offset:6144
    v_mfma_f32_16x16x32_bf16 v[132:135], v[52:55], v[32:35], v[132:135]
    ds_read_b64_tr_b16 v[80:81], v22 offset:8192
    v_mfma_f32_16x16x32_bf16 v[148:151], v[52:55], v[36:39], v[148:151]
    ds_read_b64_tr_b16 v[82:83], v22 offset:9216
    v_mfma_f32_16x16x32_bf16 v[164:167], v[52:55], v[40:43], v[164:167]
    ds_read_b64_tr_b16 v[84:85], v23 offset:8192
    v_mfma_f32_16x16x32_bf16 v[180:183], v[52:55], v[44:47], v[180:183]
    ds_read_b64_tr_b16 v[86:87], v23 offset:9216
    v_mfma_f32_16x16x32_bf16 v[136:139], v[56:59], v[32:35], v[136:139]
    ds_read_b64_tr_b16 v[88:89], v24 offset:8192
    v_mfma_f32_16x16x32_bf16 v[152:155], v[56:59], v[36:39], v[152:155]
    ds_read_b64_tr_b16 v[90:91], v24 offset:9216
    v_mfma_f32_16x16x32_bf16 v[168:171], v[56:59], v[40:43], v[168:171]
    ds_read_b64_tr_b16 v[92:93], v25 offset:8192
    v_mfma_f32_16x16x32_bf16 v[184:187], v[56:59], v[44:47], v[184:187]
    ds_read_b64_tr_b16 v[94:95], v25 offset:9216
    v_mfma_f32_16x16x32_bf16 v[140:143], v[60:63], v[32:35], v[140:143]
    v_mfma_f32_16x16x32_bf16 v[156:159], v[60:63], v[36:39], v[156:159]
    v_mfma_f32_16x16x32_bf16 v[172:175], v[60:63], v[40:43], v[172:175]
    v_mfma_f32_16x16x32_bf16 v[188:191], v[60:63], v[44:47], v[188:191]
    s_waitcnt vmcnt(32) lgkmcnt(0)
    s_barrier
    v_mfma_f32_16x16x32_bf16 v[128:131], v[80:83], v[64:67], v[128:131]
    ds_read_b128 v[32:35], v16 offset:32768
    v_mfma_f32_16x16x32_bf16 v[144:147], v[80:83], v[68:71], v[144:147]
    ds_read_b128 v[36:39], v16 offset:34816
    v_mfma_f32_16x16x32_bf16 v[160:163], v[80:83], v[72:75], v[160:163]
    ds_read_b128 v[40:43], v16 offset:36864
    v_mfma_f32_16x16x32_bf16 v[176:179], v[80:83], v[76:79], v[176:179]
    ds_read_b128 v[44:47], v16 offset:38912
    v_mfma_f32_16x16x32_bf16 v[132:135], v[84:87], v[64:67], v[132:135]
    ds_read_b64_tr_b16 v[48:49], v22 offset:32768
    v_mfma_f32_16x16x32_bf16 v[148:151], v[84:87], v[68:71], v[148:151]
    ds_read_b64_tr_b16 v[50:51], v22 offset:33792
    v_mfma_f32_16x16x32_bf16 v[164:167], v[84:87], v[72:75], v[164:167]
    ds_read_b64_tr_b16 v[52:53], v23 offset:32768
    v_mfma_f32_16x16x32_bf16 v[180:183], v[84:87], v[76:79], v[180:183]
    ds_read_b64_tr_b16 v[54:55], v23 offset:33792
    v_mfma_f32_16x16x32_bf16 v[136:139], v[88:91], v[64:67], v[136:139]
    ds_read_b64_tr_b16 v[56:57], v24 offset:32768
    v_mfma_f32_16x16x32_bf16 v[152:155], v[88:91], v[68:71], v[152:155]
    ds_read_b64_tr_b16 v[58:59], v24 offset:33792
    v_mfma_f32_16x16x32_bf16 v[168:171], v[88:91], v[72:75], v[168:171]
    ds_read_b64_tr_b16 v[60:61], v25 offset:32768
    v_mfma_f32_16x16x32_bf16 v[184:187], v[88:91], v[76:79], v[184:187]
    ds_read_b64_tr_b16 v[62:63], v25 offset:33792
    v_mfma_f32_16x16x32_bf16 v[140:143], v[92:95], v[64:67], v[140:143]
    v_mfma_f32_16x16x32_bf16 v[156:159], v[92:95], v[68:71], v[156:159]
    v_mfma_f32_16x16x32_bf16 v[172:175], v[92:95], v[72:75], v[172:175]
    v_mfma_f32_16x16x32_bf16 v[188:191], v[92:95], v[76:79], v[188:191]
    s_waitcnt lgkmcnt(0)
    v_mfma_f32_16x16x32_bf16 v[128:131], v[48:51], v[32:35], v[128:131]
    ds_read_b128 v[64:67], v17 offset:32768
    v_mfma_f32_16x16x32_bf16 v[144:147], v[48:51], v[36:39], v[144:147]
    ds_read_b128 v[68:71], v17 offset:34816
    v_mfma_f32_16x16x32_bf16 v[160:163], v[48:51], v[40:43], v[160:163]
    ds_read_b128 v[72:75], v17 offset:36864
    v_mfma_f32_16x16x32_bf16 v[176:179], v[48:51], v[44:47], v[176:179]
    ds_read_b128 v[76:79], v17 offset:38912
    v_mfma_f32_16x16x32_bf16 v[132:135], v[52:55], v[32:35], v[132:135]
    ds_read_b64_tr_b16 v[80:81], v22 offset:40960
    v_mfma_f32_16x16x32_bf16 v[148:151], v[52:55], v[36:39], v[148:151]
    ds_read_b64_tr_b16 v[82:83], v22 offset:41984
    v_mfma_f32_16x16x32_bf16 v[164:167], v[52:55], v[40:43], v[164:167]
    ds_read_b64_tr_b16 v[84:85], v23 offset:40960
    v_mfma_f32_16x16x32_bf16 v[180:183], v[52:55], v[44:47], v[180:183]
    ds_read_b64_tr_b16 v[86:87], v23 offset:41984
    v_mfma_f32_16x16x32_bf16 v[136:139], v[56:59], v[32:35], v[136:139]
    ds_read_b64_tr_b16 v[88:89], v24 offset:40960
    v_mfma_f32_16x16x32_bf16 v[152:155], v[56:59], v[36:39], v[152:155]
    ds_read_b64_tr_b16 v[90:91], v24 offset:41984
    v_mfma_f32_16x16x32_bf16 v[168:171], v[56:59], v[40:43], v[168:171]
    ds_read_b64_tr_b16 v[92:93], v25 offset:40960
    v_mfma_f32_16x16x32_bf16 v[184:187], v[56:59], v[44:47], v[184:187]
    ds_read_b64_tr_b16 v[94:95], v25 offset:41984
    v_mfma_f32_16x16x32_bf16 v[140:143], v[60:63], v[32:35], v[140:143]
    v_mfma_f32_16x16x32_bf16 v[156:159], v[60:63], v[36:39], v[156:159]
    v_mfma_f32_16x16x32_bf16 v[172:175], v[60:63], v[40:43], v[172:175]
    v_mfma_f32_16x16x32_bf16 v[188:191], v[60:63], v[44:47], v[188:191]
    s_waitcnt lgkmcnt(0)
    v_mfma_f32_16x16x32_bf16 v[128:131], v[80:83], v[64:67], v[128:131]
    v_mfma_f32_16x16x32_bf16 v[144:147], v[80:83], v[68:71], v[144:147]
    v_mfma_f32_16x16x32_bf16 v[160:163], v[80:83], v[72:75], v[160:163]
    v_mfma_f32_16x16x32_bf16 v[176:179], v[80:83], v[76:79], v[176:179]
    v_mfma_f32_16x16x32_bf16 v[132:135], v[84:87], v[64:67], v[132:135]
    v_mfma_f32_16x16x32_bf16 v[148:151], v[84:87], v[68:71], v[148:151]
    v_mfma_f32_16x16x32_bf16 v[164:167], v[84:87], v[72:75], v[164:167]
    v_mfma_f32_16x16x32_bf16 v[180:183], v[84:87], v[76:79], v[180:183]
    v_mfma_f32_16x16x32_bf16 v[136:139], v[88:91], v[64:67], v[136:139]
    v_mfma_f32_16x16x32_bf16 v[152:155], v[88:91], v[68:71], v[152:155]
    v_mfma_f32_16x16x32_bf16 v[168:171], v[88:91], v[72:75], v[168:171]
    v_mfma_f32_16x16x32_bf16 v[184:187], v[88:91], v[76:79], v[184:187]
    v_mfma_f32_16x16x32_bf16 v[140:143], v[92:95], v[64:67], v[140:143]
    v_mfma_f32_16x16x32_bf16 v[156:159], v[92:95], v[68:71], v[156:159]
    v_mfma_f32_16x16x32_bf16 v[172:175], v[92:95], v[72:75], v[172:175]
    v_mfma_f32_16x16x32_bf16 v[188:191], v[92:95], v[76:79], v[188:191]
    s_nop 15
    s_branch K5_GOT
K5_NOPRE:
    s_waitcnt lgkmcnt(0)
    v_mfma_f32_16x16x32_bf16 v[128:131], v[48:51], v[32:35], v[128:131]
    ds_read_b128 v[64:67], v17 offset:0
    v_mfma_f32_16x16x32_bf16 v[144:147], v[48:51], v[36:39], v[144:147]
    ds_read_b128 v[68:71], v17 offset:2048
    v_mfma_f32_16x16x32_bf16 v[160:163], v[48:51], v[40:43], v[160:163]
    ds_read_b128 v[72:75], v17 offset:4096
    v_mfma_f32_16x16x32_bf16 v[176:179], v[48:51], v[44:47], v[176:179]
    ds_read_b128 v[76:79], v17 offset:6144
    v_mfma_f32_16x16x32_bf16 v[132:135], v[52:55], v[32:35], v[132:135]
    ds_read_b64_tr_b16 v[80:81], v22 offset:8192
    v_mfma_f32_16x16x32_bf16 v[148:151], v[52:55], v[36:39], v[148:151]
    ds_read_b64_tr_b16 v[82:83], v22 offset:9216
    v_mfma_f32_16x16x32_bf16 v[164:167], v[52:55], v[40:43], v[164:167]
    ds_read_b64_tr_b16 v[84:85], v23 offset:8192
    v_mfma_f32_16x16x32_bf16 v[180:183], v[52:55], v[44:47], v[180:183]
    ds_read_b64_tr_b16 v[86:87], v23 offset:9216
    v_mfma_f32_16x16x32_bf16 v[136:139], v[56:59], v[32:35], v[136:139]
    ds_read_b64_tr_b16 v[88:89], v24 offset:8192
    v_mfma_f32_16x16x32_bf16 v[152:155], v[56:59], v[36:39], v[152:155]
    ds_read_b64_tr_b16 v[90:91], v24 offset:9216
    v_mfma_f32_16x16x32_bf16 v[168:171], v[56:59], v[40:43], v[168:171]
    ds_read_b64_tr_b16 v[92:93], v25 offset:8192
    v_mfma_f32_16x16x32_bf16 v[184:187], v[56:59], v[44:47], v[184:187]
    ds_read_b64_tr_b16 v[94:95], v25 offset:9216
    v_mfma_f32_16x16x32_bf16 v[140:143], v[60:63], v[32:35], v[140:143]
    v_mfma_f32_16x16x32_bf16 v[156:159], v[60:63], v[36:39], v[156:159]
    v_mfma_f32_16x16x32_bf16 v[172:175], v[60:63], v[40:43], v[172:175]
    v_mfma_f32_16x16x32_bf16 v[188:191], v[60:63], v[44:47], v[188:191]
    s_waitcnt vmcnt(0) lgkmcnt(0)
    s_barrier
    v_mfma_f32_16x16x32_bf16 v[128:131], v[80:83], v[64:67], v[128:131]
    ds_read_b128 v[32:35], v16 offset:32768
    v_mfma_f32_16x16x32_bf16 v[144:147], v[80:83], v[68:71], v[144:147]
    ds_read_b128 v[36:39], v16 offset:34816
    v_mfma_f32_16x16x32_bf16 v[160:163], v[80:83], v[72:75], v[160:163]
    ds_read_b128 v[40:43], v16 offset:36864
    v_mfma_f32_16x16x32_bf16 v[176:179], v[80:83], v[76:79], v[176:179]
    ds_read_b128 v[44:47], v16 offset:38912
    v_mfma_f32_16x16x32_bf16 v[132:135], v[84:87], v[64:67], v[132:135]
    ds_read_b64_tr_b16 v[48:49], v22 offset:32768
    v_mfma_f32_16x16x32_bf16 v[148:151], v[84:87], v[68:71], v[148:151]
    ds_read_b64_tr_b16 v[50:51], v22 offset:33792
    v_mfma_f32_16x16x32_bf16 v[164:167], v[84:87], v[72:75], v[164:167]
    ds_read_b64_tr_b16 v[52:53], v23 offset:32768
    v_mfma_f32_16x16x32_bf16 v[180:183], v[84:87], v[76:79], v[180:183]
    ds_read_b64_tr_b16 v[54:55], v23 offset:33792
    v_mfma_f32_16x16x32_bf16 v[136:139], v[88:91], v[64:67], v[136:139]
    ds_read_b64_tr_b16 v[56:57], v24 offset:32768
    v_mfma_f32_16x16x32_bf16 v[152:155], v[88:91], v[68:71], v[152:155]
    ds_read_b64_tr_b16 v[58:59], v24 offset:33792
    v_mfma_f32_16x16x32_bf16 v[168:171], v[88:91], v[72:75], v[168:171]
    ds_read_b64_tr_b16 v[60:61], v25 offset:32768
    v_mfma_f32_16x16x32_bf16 v[184:187], v[88:91], v[76:79], v[184:187]
    ds_read_b64_tr_b16 v[62:63], v25 offset:33792
    v_mfma_f32_16x16x32_bf16 v[140:143], v[92:95], v[64:67], v[140:143]
    v_mfma_f32_16x16x32_bf16 v[156:159], v[92:95], v[68:71], v[156:159]
    v_mfma_f32_16x16x32_bf16 v[172:175], v[92:95], v[72:75], v[172:175]
    v_mfma_f32_16x16x32_bf16 v[188:191], v[92:95], v[76:79], v[188:191]
    s_waitcnt lgkmcnt(0)
    v_mfma_f32_16x16x32_bf16 v[128:131], v[48:51], v[32:35], v[128:131]
    ds_read_b128 v[64:67], v17 offset:32768
    v_mfma_f32_16x16x32_bf16 v[144:147], v[48:51], v[36:39], v[144:147]
    ds_read_b128 v[68:71], v17 offset:34816
    v_mfma_f32_16x16x32_bf16 v[160:163], v[48:51], v[40:43], v[160:163]
    ds_read_b128 v[72:75], v17 offset:36864
    v_mfma_f32_16x16x32_bf16 v[176:179], v[48:51], v[44:47], v[176:179]
    ds_read_b128 v[76:79], v17 offset:38912
    v_mfma_f32_16x16x32_bf16 v[132:135], v[52:55], v[32:35], v[132:135]
    ds_read_b64_tr_b16 v[80:81], v22 offset:40960
    v_mfma_f32_16x16x32_bf16 v[148:151], v[52:55], v[36:39], v[148:151]
    ds_read_b64_tr_b16 v[82:83], v22 offset:41984
    v_mfma_f32_16x16x32_bf16 v[164:167], v[52:55], v[40:43], v[164:167]
    ds_read_b64_tr_b16 v[84:85], v23 offset:40960
    v_mfma_f32_16x16x32_bf16 v[180:183], v[52:55], v[44:47], v[180:183]
    ds_read_b64_tr_b16 v[86:87], v23 offset:41984
    v_mfma_f32_16x16x32_bf16 v[136:139], v[56:59], v[32:35], v[136:139]
    ds_read_b64_tr_b16 v[88:89], v24 offset:40960
    v_mfma_f32_16x16x32_bf16 v[152:155], v[56:59], v[36:39], v[152:155]
    ds_read_b64_tr_b16 v[90:91], v24 offset:41984
    v_mfma_f32_16x16x32_bf16 v[168:171], v[56:59], v[40:43], v[168:171]
    ds_read_b64_tr_b16 v[92:93], v25 offset:40960
    v_mfma_f32_16x16x32_bf16 v[184:187], v[56:59], v[44:47], v[184:187]
    ds_read_b64_tr_b16 v[94:95], v25 offset:41984
    v_mfma_f32_16x16x32_bf16 v[140:143], v[60:63], v[32:35], v[140:143]
    v_mfma_f32_16x16x32_bf16 v[156:159], v[60:63], v[36:39], v[156:159]
    v_mfma_f32_16x16x32_bf16 v[172:175], v[60:63], v[40:43], v[172:175]
    v_mfma_f32_16x16x32_bf16 v[188:191], v[60:63], v[44:47], v[188:191]
    s_waitcnt lgkmcnt(0)
    v_mfma_f32_16x16x32_bf16 v[128:131], v[80:83], v[64:67], v[128:131]
    v_mfma_f32_16x16x32_bf16 v[144:147], v[80:83], v[68:71], v[144:147]
    v_mfma_f32_16x16x32_bf16 v[160:163], v[80:83], v[72:75], v[160:163]
    v_mfma_f32_16x16x32_bf16 v[176:179], v[80:83], v[76:79], v[176:179]
    v_mfma_f32_16x16x32_bf16 v[132:135], v[84:87], v[64:67], v[132:135]
    v_mfma_f32_16x16x32_bf16 v[148:151], v[84:87], v[68:71], v[148:151]
    v_mfma_f32_16x16x32_bf16 v[164:167], v[84:87], v[72:75], v[164:167]
    v_mfma_f32_16x16x32_bf16 v[180:183], v[84:87], v[76:79], v[180:183]
    v_mfma_f32_16x16x32_bf16 v[136:139], v[88:91], v[64:67], v[136:139]
    v_mfma_f32_16x16x32_bf16 v[152:155], v[88:91], v[68:71], v[152:155]
    v_mfma_f32_16x16x32_bf16 v[168:171], v[88:91], v[72:75], v[168:171]
    v_mfma_f32_16x16x32_bf16 v[184:187], v[88:91], v[76:79], v[184:187]
    v_mfma_f32_16x16x32_bf16 v[140:143], v[92:95], v[64:67], v[140:143]
    v_mfma_f32_16x16x32_bf16 v[156:159], v[92:95], v[68:71], v[156:159]
    v_mfma_f32_16x16x32_bf16 v[172:175], v[92:95], v[72:75], v[172:175]
    v_mfma_f32_16x16x32_bf16 v[188:191], v[92:95], v[76:79], v[188:191]
    s_nop 15
    s_lshl_b32 s34, s39, 16
    s_lshl_b32 s3, s27, 14
    s_add_u32 s34, s34, s3
    s_cmp_eq_u32 s38, 1
    s_cbranch_scc1 K5_SECOND
    s_add_u32 s33, s34, 0
    buffer_store_dwordx4 v[128:131], v27, s[20:23], s33 offen sc1
    s_add_u32 s33, s34, 1024
    buffer_store_dwordx4 v[132:135], v27, s[20:23], s33 offen sc1
    s_add_u32 s33, s34, 2048
    buffer_store_dwordx4 v[136:139], v27, s[20:23], s33 offen sc1
    s_add_u32 s33, s34, 3072
    buffer_store_dwordx4 v[140:143], v27, s[20:23], s33 offen sc1
    s_add_u32 s33, s34, 4096
    buffer_store_dwordx4 v[144:147], v27, s[20:23], s33 offen sc1
    s_add_u32 s33, s34, 5120
    buffer_store_dwordx4 v[148:151], v27, s[20:23], s33 offen sc1
    s_add_u32 s33, s34, 6144
    buffer_store_dwordx4 v[152:155], v27, s[20:23], s33 offen sc1
    s_add_u32 s33, s34, 7168
    buffer_store_dwordx4 v[156:159], v27, s[20:23], s33 offen sc1
    s_add_u32 s33, s34, 8192
    buffer_store_dwordx4 v[160:163], v27, s[20:23], s33 offen sc1
    s_add_u32 s33, s34, 9216
    buffer_store_dwordx4 v[164:167], v27, s[20:23], s33 offen sc1
    s_add_u32 s33, s34, 10240
    buffer_store_dwordx4 v[168:171], v27, s[20:23], s33 offen sc1
    s_add_u32 s33, s34, 11264
    buffer_store_dwordx4 v[172:175], v27, s[20:23], s33 offen sc1
    s_add_u32 s33, s34, 12288
    buffer_store_dwordx4 v[176:179], v27, s[20:23], s33 offen sc1
    s_add_u32 s33, s34, 13312
    buffer_store_dwordx4 v[180:183], v27, s[20:23], s33 offen sc1
    s_add_u32 s33, s34, 14336
    buffer_store_dwordx4 v[184:187], v27, s[20:23], s33 offen sc1
    s_add_u32 s33, s34, 15360
    buffer_store_dwordx4 v[188:191], v27, s[20:23], s33 offen sc1
    s_waitcnt vmcnt(0)
    s_barrier
    s_cmp_lg_u32 s27, 0
    s_cbranch_scc1 K5_END
    v_mov_b32 v6, s43
    v_mov_b32 v7, s40
    s_mov_b64 exec, 1
    buffer_atomic_add v6, v7, s[44:47], 0 offen sc1
    s_waitcnt vmcnt(0)
    s_branch K5_END
K5_SECOND:
    s_cmp_eq_u32 s59, 1
    s_cbranch_scc1 K5_GOT
    v_mov_b32 v7, s40
K5_POLL:
    buffer_load_dword v6, v7, s[44:47], 0 offen sc1
    s_waitcnt vmcnt(0)
    s_nop 0
    v_readfirstlane_b32 s35, v6
    s_nop 3
    s_and_b32 s35, s35, s43
    s_cmp_lg_u32 s35, 0
    s_cbranch_scc1 K5_POLL_DONE
    s_sleep 2
    s_branch K5_POLL
K5_POLL_DONE:
    s_lshl_b32 s34, s39, 16
    s_lshl_b32 s3, s27, 14
    s_add_u32 s34, s34, s3
    s_add_u32 s33, s34, 0
    buffer_load_dwordx4 v[192:195], v27, s[20:23], s33 offen sc1
    s_add_u32 s33, s34, 1024
    buffer_load_dwordx4 v[196:199], v27, s[20:23], s33 offen sc1
    s_add_u32 s33, s34, 2048
    buffer_load_dwordx4 v[200:203], v27, s[20:23], s33 offen sc1
    s_add_u32 s33, s34, 3072
    buffer_load_dwordx4 v[204:207], v27, s[20:23], s33 offen sc1
    s_add_u32 s33, s34, 4096
    buffer_load_dwordx4 v[208:211], v27, s[20:23], s33 offen sc1
    s_add_u32 s33, s34, 5120
    buffer_load_dwordx4 v[212:215], v27, s[20:23], s33 offen sc1
    s_add_u32 s33, s34, 6144
    buffer_load_dwordx4 v[216:219], v27, s[20:23], s33 offen sc1
    s_add_u32 s33, s34, 7168
    buffer_load_dwordx4 v[220:223], v27, s[20:23], s33 offen sc1
    s_add_u32 s33, s34, 8192
    buffer_load_dwordx4 v[224:227], v27, s[20:23], s33 offen sc1
    s_add_u32 s33, s34, 9216
    buffer_load_dwordx4 v[228:231], v27, s[20:23], s33 offen sc1
    s_add_u32 s33, s34, 10240
    buffer_load_dwordx4 v[232:235], v27, s[20:23], s33 offen sc1
    s_add_u32 s33, s34, 11264
    buffer_load_dwordx4 v[236:239], v27, s[20:23], s33 offen sc1
    s_add_u32 s33, s34, 12288
    buffer_load_dwordx4 v[240:243], v27, s[20:23], s33 offen sc1
    s_add_u32 s33, s34, 13312
    buffer_load_dwordx4 v[244:247], v27, s[20:23], s33 offen sc1
    s_add_u32 s33, s34, 14336
    buffer_load_dwordx4 v[248:251], v27, s[20:23], s33 offen sc1
    s_add_u32 s33, s34, 15360
    buffer_load_dwordx4 v[252:255], v27, s[20:23], s33 offen sc1
    s_lshl_b32 s42, s52, 18
    s_lshl_b32 s3, s53, 8
    s_add_u32 s42, s42, s3
    s_add_u32 s48, s42, 0
    s_add_u32 s49, s42, 32768
    s_add_u32 s50, s42, 65536
    s_add_u32 s51, s42, 98304
    buffer_load_dwordx2 v[96:97], v26, s[16:19], s48 offen offset:0
    buffer_load_dwordx2 v[98:99], v26, s[16:19], s48 offen offset:32
    buffer_load_dwordx2 v[100:101], v26, s[16:19], s48 offen offset:64
    buffer_load_dwordx2 v[102:103], v26, s[16:19], s48 offen offset:96
    buffer_load_dwordx2 v[104:105], v26, s[16:19], s49 offen offset:0
    buffer_load_dwordx2 v[106:107], v26, s[16:19], s49 offen offset:32
    buffer_load_dwordx2 v[108:109], v26, s[16:19], s49 offen offset:64
    buffer_load_dwordx2 v[110:111], v26, s[16:19], s49 offen offset:96
    buffer_load_dwordx2 v[112:113], v26, s[16:19], s50 offen offset:0
    buffer_load_dwordx2 v[114:115], v26, s[16:19], s50 offen offset:32
    buffer_load_dwordx2 v[116:117], v26, s[16:19], s50 offen offset:64
    buffer_load_dwordx2 v[118:119], v26, s[16:19], s50 offen offset:96
    buffer_load_dwordx2 v[120:121], v26, s[16:19], s51 offen offset:0
    buffer_load_dwordx2 v[122:123], v26, s[16:19], s51 offen offset:32
    buffer_load_dwordx2 v[124:125], v26, s[16:19], s51 offen offset:64
    buffer_load_dwordx2 v[126:127], v26, s[16:19], s51 offen offset:96
K5_GOT:
    s_waitcnt vmcnt(0)
    v_pk_add_f32 v[128:129], v[128:129], v[192:193]
    v_pk_add_f32 v[130:131], v[130:131], v[194:195]
    v_cvt_pk_bf16_f32 v6, v128, v129
    v_lshlrev_b32 v8, 16, v96
    v_and_b32 v9, 0xffff0000, v96
    v_and_b32 v7, 0xffff0000, v6
    v_lshlrev_b32 v6, 16, v6
    v_pk_add_f32 v[6:7], v[6:7], v[8:9]
    v_cvt_pk_bf16_f32 v96, v6, v7
    v_cvt_pk_bf16_f32 v6, v130, v131
    v_lshlrev_b32 v8, 16, v97
    v_and_b32 v9, 0xffff0000, v97
    v_and_b32 v7, 0xffff0000, v6
    v_lshlrev_b32 v6, 16, v6
    v_pk_add_f32 v[6:7], v[6:7], v[8:9]
    v_cvt_pk_bf16_f32 v97, v6, v7
    buffer_store_dwordx2 v[96:97], v26, s[16:19], s48 offen offset:0
    v_pk_add_f32 v[132:133], v[132:133], v[196:197]
    v_pk_add_f32 v[134:135], v[134:135], v[198:199]
    v_cvt_pk_bf16_f32 v6, v132, v133
    v_lshlrev_b32 v8, 16, v98
    v_and_b32 v9, 0xffff0000, v98
    v_and_b32 v7, 0xffff0000, v6
    v_lshlrev_b32 v6, 16, v6
    v_pk_add_f32 v[6:7], v[6:7], v[8:9]
    v_cvt_pk_bf16_f32 v98, v6, v7
    v_cvt_pk_bf16_f32 v6, v134, v135
    v_lshlrev_b32 v8, 16, v99
    v_and_b32 v9, 0xffff0000, v99
    v_and_b32 v7, 0xffff0000, v6
    v_lshlrev_b32 v6, 16, v6
    v_pk_add_f32 v[6:7], v[6:7], v[8:9]
    v_cvt_pk_bf16_f32 v99, v6, v7
    buffer_store_dwordx2 v[98:99], v26, s[16:19], s48 offen offset:32
    v_pk_add_f32 v[136:137], v[136:137], v[200:201]
    v_pk_add_f32 v[138:139], v[138:139], v[202:203]
    v_cvt_pk_bf16_f32 v6, v136, v137
    v_lshlrev_b32 v8, 16, v100
    v_and_b32 v9, 0xffff0000, v100
    v_and_b32 v7, 0xffff0000, v6
    v_lshlrev_b32 v6, 16, v6
    v_pk_add_f32 v[6:7], v[6:7], v[8:9]
    v_cvt_pk_bf16_f32 v100, v6, v7
    v_cvt_pk_bf16_f32 v6, v138, v139
    v_lshlrev_b32 v8, 16, v101
    v_and_b32 v9, 0xffff0000, v101
    v_and_b32 v7, 0xffff0000, v6
    v_lshlrev_b32 v6, 16, v6
    v_pk_add_f32 v[6:7], v[6:7], v[8:9]
    v_cvt_pk_bf16_f32 v101, v6, v7
    buffer_store_dwordx2 v[100:101], v26, s[16:19], s48 offen offset:64
    v_pk_add_f32 v[140:141], v[140:141], v[204:205]
    v_pk_add_f32 v[142:143], v[142:143], v[206:207]
    v_cvt_pk_bf16_f32 v6, v140, v141
    v_lshlrev_b32 v8, 16, v102
    v_and_b32 v9, 0xffff0000, v102
    v_and_b32 v7, 0xffff0000, v6
    v_lshlrev_b32 v6, 16, v6
    v_pk_add_f32 v[6:7], v[6:7], v[8:9]
    v_cvt_pk_bf16_f32 v102, v6, v7
    v_cvt_pk_bf16_f32 v6, v142, v143
    v_lshlrev_b32 v8, 16, v103
    v_and_b32 v9, 0xffff0000, v103
    v_and_b32 v7, 0xffff0000, v6
    v_lshlrev_b32 v6, 16, v6
    v_pk_add_f32 v[6:7], v[6:7], v[8:9]
    v_cvt_pk_bf16_f32 v103, v6, v7
    buffer_store_dwordx2 v[102:103], v26, s[16:19], s48 offen offset:96
    v_pk_add_f32 v[144:145], v[144:145], v[208:209]
    v_pk_add_f32 v[146:147], v[146:147], v[210:211]
    v_cvt_pk_bf16_f32 v6, v144, v145
    v_lshlrev_b32 v8, 16, v104
    v_and_b32 v9, 0xffff0000, v104
    v_and_b32 v7, 0xffff0000, v6
    v_lshlrev_b32 v6, 16, v6
    v_pk_add_f32 v[6:7], v[6:7], v[8:9]
    v_cvt_pk_bf16_f32 v104, v6, v7
    v_cvt_pk_bf16_f32 v6, v146, v147
    v_lshlrev_b32 v8, 16, v105
    v_and_b32 v9, 0xffff0000, v105
    v_and_b32 v7, 0xffff0000, v6
    v_lshlrev_b32 v6, 16, v6
    v_pk_add_f32 v[6:7], v[6:7], v[8:9]
    v_cvt_pk_bf16_f32 v105, v6, v7
    buffer_store_dwordx2 v[104:105], v26, s[16:19], s49 offen offset:0
    v_pk_add_f32 v[148:149], v[148:149], v[212:213]
    v_pk_add_f32 v[150:151], v[150:151], v[214:215]
    v_cvt_pk_bf16_f32 v6, v148, v149
    v_lshlrev_b32 v8, 16, v106
    v_and_b32 v9, 0xffff0000, v106
    v_and_b32 v7, 0xffff0000, v6
    v_lshlrev_b32 v6, 16, v6
    v_pk_add_f32 v[6:7], v[6:7], v[8:9]
    v_cvt_pk_bf16_f32 v106, v6, v7
    v_cvt_pk_bf16_f32 v6, v150, v151
    v_lshlrev_b32 v8, 16, v107
    v_and_b32 v9, 0xffff0000, v107
    v_and_b32 v7, 0xffff0000, v6
    v_lshlrev_b32 v6, 16, v6
    v_pk_add_f32 v[6:7], v[6:7], v[8:9]
    v_cvt_pk_bf16_f32 v107, v6, v7
    buffer_store_dwordx2 v[106:107], v26, s[16:19], s49 offen offset:32
    v_pk_add_f32 v[152:153], v[152:153], v[216:217]
    v_pk_add_f32 v[154:155], v[154:155], v[218:219]
    v_cvt_pk_bf16_f32 v6, v152, v153
    v_lshlrev_b32 v8, 16, v108
    v_and_b32 v9, 0xffff0000, v108
    v_and_b32 v7, 0xffff0000, v6
    v_lshlrev_b32 v6, 16, v6
    v_pk_add_f32 v[6:7], v[6:7], v[8:9]
    v_cvt_pk_bf16_f32 v108, v6, v7
    v_cvt_pk_bf16_f32 v6, v154, v155
    v_lshlrev_b32 v8, 16, v109
    v_and_b32 v9, 0xffff0000, v109
    v_and_b32 v7, 0xffff0000, v6
    v_lshlrev_b32 v6, 16, v6
    v_pk_add_f32 v[6:7], v[6:7], v[8:9]
    v_cvt_pk_bf16_f32 v109, v6, v7
    buffer_store_dwordx2 v[108:109], v26, s[16:19], s49 offen offset:64
    v_pk_add_f32 v[156:157], v[156:157], v[220:221]
    v_pk_add_f32 v[158:159], v[158:159], v[222:223]
    v_cvt_pk_bf16_f32 v6, v156, v157
    v_lshlrev_b32 v8, 16, v110
    v_and_b32 v9, 0xffff0000, v110
    v_and_b32 v7, 0xffff0000, v6
    v_lshlrev_b32 v6, 16, v6
    v_pk_add_f32 v[6:7], v[6:7], v[8:9]
    v_cvt_pk_bf16_f32 v110, v6, v7
    v_cvt_pk_bf16_f32 v6, v158, v159
    v_lshlrev_b32 v8, 16, v111
    v_and_b32 v9, 0xffff0000, v111
    v_and_b32 v7, 0xffff0000, v6
    v_lshlrev_b32 v6, 16, v6
    v_pk_add_f32 v[6:7], v[6:7], v[8:9]
    v_cvt_pk_bf16_f32 v111, v6, v7
    buffer_store_dwordx2 v[110:111], v26, s[16:19], s49 offen offset:96
    v_pk_add_f32 v[160:161], v[160:161], v[224:225]
    v_pk_add_f32 v[162:163], v[162:163], v[226:227]
    v_cvt_pk_bf16_f32 v6, v160, v161
    v_lshlrev_b32 v8, 16, v112
    v_and_b32 v9, 0xffff0000, v112
    v_and_b32 v7, 0xffff0000, v6
    v_lshlrev_b32 v6, 16, v6
    v_pk_add_f32 v[6:7], v[6:7], v[8:9]
    v_cvt_pk_bf16_f32 v112, v6, v7
    v_cvt_pk_bf16_f32 v6, v162, v163
    v_lshlrev_b32 v8, 16, v113
    v_and_b32 v9, 0xffff0000, v113
    v_and_b32 v7, 0xffff0000, v6
    v_lshlrev_b32 v6, 16, v6
    v_pk_add_f32 v[6:7], v[6:7], v[8:9]
    v_cvt_pk_bf16_f32 v113, v6, v7
    buffer_store_dwordx2 v[112:113], v26, s[16:19], s50 offen offset:0
    v_pk_add_f32 v[164:165], v[164:165], v[228:229]
    v_pk_add_f32 v[166:167], v[166:167], v[230:231]
    v_cvt_pk_bf16_f32 v6, v164, v165
    v_lshlrev_b32 v8, 16, v114
    v_and_b32 v9, 0xffff0000, v114
    v_and_b32 v7, 0xffff0000, v6
    v_lshlrev_b32 v6, 16, v6
    v_pk_add_f32 v[6:7], v[6:7], v[8:9]
    v_cvt_pk_bf16_f32 v114, v6, v7
    v_cvt_pk_bf16_f32 v6, v166, v167
    v_lshlrev_b32 v8, 16, v115
    v_and_b32 v9, 0xffff0000, v115
    v_and_b32 v7, 0xffff0000, v6
    v_lshlrev_b32 v6, 16, v6
    v_pk_add_f32 v[6:7], v[6:7], v[8:9]
    v_cvt_pk_bf16_f32 v115, v6, v7
    buffer_store_dwordx2 v[114:115], v26, s[16:19], s50 offen offset:32
    v_pk_add_f32 v[168:169], v[168:169], v[232:233]
    v_pk_add_f32 v[170:171], v[170:171], v[234:235]
    v_cvt_pk_bf16_f32 v6, v168, v169
    v_lshlrev_b32 v8, 16, v116
    v_and_b32 v9, 0xffff0000, v116
    v_and_b32 v7, 0xffff0000, v6
    v_lshlrev_b32 v6, 16, v6
    v_pk_add_f32 v[6:7], v[6:7], v[8:9]
    v_cvt_pk_bf16_f32 v116, v6, v7
    v_cvt_pk_bf16_f32 v6, v170, v171
    v_lshlrev_b32 v8, 16, v117
    v_and_b32 v9, 0xffff0000, v117
    v_and_b32 v7, 0xffff0000, v6
    v_lshlrev_b32 v6, 16, v6
    v_pk_add_f32 v[6:7], v[6:7], v[8:9]
    v_cvt_pk_bf16_f32 v117, v6, v7
    buffer_store_dwordx2 v[116:117], v26, s[16:19], s50 offen offset:64
    v_pk_add_f32 v[172:173], v[172:173], v[236:237]
    v_pk_add_f32 v[174:175], v[174:175], v[238:239]
    v_cvt_pk_bf16_f32 v6, v172, v173
    v_lshlrev_b32 v8, 16, v118
    v_and_b32 v9, 0xffff0000, v118
    v_and_b32 v7, 0xffff0000, v6
    v_lshlrev_b32 v6, 16, v6
    v_pk_add_f32 v[6:7], v[6:7], v[8:9]
    v_cvt_pk_bf16_f32 v118, v6, v7
    v_cvt_pk_bf16_f32 v6, v174, v175
    v_lshlrev_b32 v8, 16, v119
    v_and_b32 v9, 0xffff0000, v119
    v_and_b32 v7, 0xffff0000, v6
    v_lshlrev_b32 v6, 16, v6
    v_pk_add_f32 v[6:7], v[6:7], v[8:9]
    v_cvt_pk_bf16_f32 v119, v6, v7
    buffer_store_dwordx2 v[118:119], v26, s[16:19], s50 offen offset:96
    v_pk_add_f32 v[176:177], v[176:177], v[240:241]
    v_pk_add_f32 v[178:179], v[178:179], v[242:243]
    v_cvt_pk_bf16_f32 v6, v176, v177
    v_lshlrev_b32 v8, 16, v120
    v_and_b32 v9, 0xffff0000, v120
    v_and_b32 v7, 0xffff0000, v6
    v_lshlrev_b32 v6, 16, v6
    v_pk_add_f32 v[6:7], v[6:7], v[8:9]
    v_cvt_pk_bf16_f32 v120, v6, v7
    v_cvt_pk_bf16_f32 v6, v178, v179
    v_lshlrev_b32 v8, 16, v121
    v_and_b32 v9, 0xffff0000, v121
    v_and_b32 v7, 0xffff0000, v6
    v_lshlrev_b32 v6, 16, v6
    v_pk_add_f32 v[6:7], v[6:7], v[8:9]
    v_cvt_pk_bf16_f32 v121, v6, v7
    buffer_store_dwordx2 v[120:121], v26, s[16:19], s51 offen offset:0
    v_pk_add_f32 v[180:181], v[180:181], v[244:245]
    v_pk_add_f32 v[182:183], v[182:183], v[246:247]
    v_cvt_pk_bf16_f32 v6, v180, v181
    v_lshlrev_b32 v8, 16, v122
    v_and_b32 v9, 0xffff0000, v122
    v_and_b32 v7, 0xffff0000, v6
    v_lshlrev_b32 v6, 16, v6
    v_pk_add_f32 v[6:7], v[6:7], v[8:9]
    v_cvt_pk_bf16_f32 v122, v6, v7
    v_cvt_pk_bf16_f32 v6, v182, v183
    v_lshlrev_b32 v8, 16, v123
    v_and_b32 v9, 0xffff0000, v123
    v_and_b32 v7, 0xffff0000, v6
    v_lshlrev_b32 v6, 16, v6
    v_pk_add_f32 v[6:7], v[6:7], v[8:9]
    v_cvt_pk_bf16_f32 v123, v6, v7
    buffer_store_dwordx2 v[122:123], v26, s[16:19], s51 offen offset:32
    v_pk_add_f32 v[184:185], v[184:185], v[248:249]
    v_pk_add_f32 v[186:187], v[186:187], v[250:251]
    v_cvt_pk_bf16_f32 v6, v184, v185
    v_lshlrev_b32 v8, 16, v124
    v_and_b32 v9, 0xffff0000, v124
    v_and_b32 v7, 0xffff0000, v6
    v_lshlrev_b32 v6, 16, v6
    v_pk_add_f32 v[6:7], v[6:7], v[8:9]
    v_cvt_pk_bf16_f32 v124, v6, v7
    v_cvt_pk_bf16_f32 v6, v186, v187
    v_lshlrev_b32 v8, 16, v125
    v_and_b32 v9, 0xffff0000, v125
    v_and_b32 v7, 0xffff0000, v6
    v_lshlrev_b32 v6, 16, v6
    v_pk_add_f32 v[6:7], v[6:7], v[8:9]
    v_cvt_pk_bf16_f32 v125, v6, v7
    buffer_store_dwordx2 v[124:125], v26, s[16:19], s51 offen offset:64
    v_pk_add_f32 v[188:189], v[188:189], v[252:253]
    v_pk_add_f32 v[190:191], v[190:191], v[254:255]
    v_cvt_pk_bf16_f32 v6, v188, v189
    v_lshlrev_b32 v8, 16, v126
    v_and_b32 v9, 0xffff0000, v126
    v_and_b32 v7, 0xffff0000, v6
    v_lshlrev_b32 v6, 16, v6
    v_pk_add_f32 v[6:7], v[6:7], v[8:9]
    v_cvt_pk_bf16_f32 v126, v6, v7
    v_cvt_pk_bf16_f32 v6, v190, v191
    v_lshlrev_b32 v8, 16, v127
    v_and_b32 v9, 0xffff0000, v127
    v_and_b32 v7, 0xffff0000, v6
    v_lshlrev_b32 v6, 16, v6
    v_pk_add_f32 v[6:7], v[6:7], v[8:9]
    v_cvt_pk_bf16_f32 v127, v6, v7
    buffer_store_dwordx2 v[126:127], v26, s[16:19], s51 offen offset:96
K5_END:
    s_endpgm
.section .rodata,"a"
.p2align 6
.amdhsa_kernel k1_kernel
  .amdhsa_next_free_vgpr 128
  .amdhsa_next_free_sgpr 102
  .amdhsa_accum_offset 128
  .amdhsa_group_segment_fixed_size 0
  .amdhsa_kernarg_size 80
  .amdhsa_user_sgpr_count 2
  .amdhsa_user_sgpr_kernarg_segment_ptr 1
  .amdhsa_system_sgpr_workgroup_id_x 1
  .amdhsa_float_denorm_mode_32 3
.end_amdhsa_kernel
.amdhsa_kernel k2_kernel
  .amdhsa_next_free_vgpr 128
  .amdhsa_next_free_sgpr 102
  .amdhsa_accum_offset 128
  .amdhsa_group_segment_fixed_size 0
  .amdhsa_kernarg_size 80
  .amdhsa_user_sgpr_count 2
  .amdhsa_user_sgpr_kernarg_segment_ptr 1
  .amdhsa_system_sgpr_workgroup_id_x 1
  .amdhsa_float_denorm_mode_32 3
.end_amdhsa_kernel
.amdhsa_kernel k3_kernel
  .amdhsa_next_free_vgpr 136
  .amdhsa_next_free_sgpr 102
  .amdhsa_accum_offset 136
  .amdhsa_group_segment_fixed_size 0
  .amdhsa_kernarg_size 80
  .amdhsa_user_sgpr_count 2
  .amdhsa_user_sgpr_kernarg_segment_ptr 1
  .amdhsa_system_sgpr_workgroup_id_x 1
  .amdhsa_float_denorm_mode_32 3
.end_amdhsa_kernel
.amdhsa_kernel k4_kernel
  .amdhsa_next_free_vgpr 256
  .amdhsa_next_free_sgpr 102
  .amdhsa_accum_offset 256
  .amdhsa_group_segment_fixed_size 0
  .amdhsa_kernarg_size 80
  .amdhsa_user_sgpr_count 2
  .amdhsa_user_sgpr_kernarg_segment_ptr 1
  .amdhsa_system_sgpr_workgroup_id_x 1
  .amdhsa_float_denorm_mode_32 3
.end_amdhsa_kernel
.amdhsa_kernel k5_kernel
  .amdhsa_next_free_vgpr 256
  .amdhsa_next_free_sgpr 102
  .amdhsa_accum_offset 256
  .amdhsa_group_segment_fixed_size 0
  .amdhsa_kernarg_size 80
  .amdhsa_user_sgpr_count 2
  .amdhsa_user_sgpr_kernarg_segment_ptr 1
  .amdhsa_system_sgpr_workgroup_id_x 1
  .amdhsa_float_denorm_mode_32 3
.end_amdhsa_kernel
```
